```python
import torch

def _softmax(x, axis=-1):
    return torch.softmax(x, dim=axis)
def _gelu(x):
    return torch.nn.functional.gelu(x, approximate="tanh")
def _silu(x):
    return torch.nn.functional.silu(x)
def _sigmoid(x):
    return torch.sigmoid(x)
def _layernorm(x, axis=-1, eps=1e-5):
    m = x.mean(dim=axis, keepdim=True)
    v = x.var(dim=axis, keepdim=True, unbiased=False)
    return (x - m) / torch.sqrt(v + eps)
def _scatter_add(tgt, idx, src, axis=0):
    return tgt.clone().index_add_(axis, idx, src)
def _segment_sum(src, seg, n):
    out = torch.zeros((n,) + src.shape[1:], dtype=src.dtype)
    return out.index_add_(0, seg, src)
def _pad(x, pw):
    flat = tuple(v for pair in reversed(pw) for v in pair)
    return torch.nn.functional.pad(x, flat)

kernel_name = 'standalone__molecular_angular_gemnet__graph'

def setup_inputs():

    _w = (lambda a: (lambda t: t.to(torch.bfloat16) if t.is_floating_point() else t)(torch.as_tensor(a)))
    N, deg, De, L = 10000, 32, 4, 3
    E = N * deg
    T = E * deg
    NR = 8
    dist = torch.rand(E).to(float)
    angle = (torch.rand(T) * torch.pi).to(float)
    centers = torch.linspace(0.0, 1.0, NR).to(float)
    ang_freq = torch.arange(1, L + 1).to(float)
    return {
        "m": _w((lambda *s: torch.randn(*s, dtype=torch.bfloat16) * 0.05)(E, De)),
        "idx_in": _w((lambda lo, hi, *s: torch.randint(lo, hi, s))(0, E, T).to(torch.int64)),
        "idx_out": _w((lambda lo, hi, *s: torch.randint(lo, hi, s))(0, E, T).to(torch.int64)),
        "dist": _w(dist),
        "angle": _w(angle),
        "centers": _w(centers),
        "ang_freq": _w(ang_freq),
        "w_rbf": _w((lambda *s: torch.randn(*s, dtype=torch.bfloat16) * 0.2)(NR, De)),
        "w_sbf": _w((lambda *s: torch.randn(*s, dtype=torch.bfloat16) * 0.2)(NR * L, De)),
        "w_down": _w((lambda *s: torch.randn(*s, dtype=torch.bfloat16) * 0.2)(De, De)),
        "w_up": _w((lambda *s: torch.randn(*s, dtype=torch.bfloat16) * 0.2)(De, De)),
    }

def reference(m, idx_in, idx_out, dist, angle, centers, ang_freq, w_rbf, w_sbf, w_down, w_up):
    E, De = m.shape[0], m.shape[1]
    NR = centers.shape[0]
    L = ang_freq.shape[0]
    rbf = torch.exp(-10.0 * (dist[:, None] - centers[None, :]) ** 2)
    cbf = torch.cos(ang_freq[None, :] * angle[:, None])
    rbf_t = rbf[idx_out]
    sbf = torch.reshape(rbf_t[:, :, None] * cbf[:, None, :], (-1, NR * L))
    x = (m[idx_in] @ w_down) * (sbf @ w_sbf)
    agg = _segment_sum(x, idx_out, E)
    return m + (agg @ w_up) * (rbf @ w_rbf)
```

```asm
; @launch kernel=p_kernel grid=(256,1,1) block=(1024,1,1) lds=138272
; @launch kernel=c_kernel grid=(256,1,1) block=(1024,1,1) lds=162560
.amdgcn_target "amdgcn-amd-amdhsa--gfx950"
.text
.globl p_kernel
.p2align 8
.type p_kernel,@function
p_kernel:
    s_cmp_ge_u32 s2, 256
    s_cbranch_scc1 Lp_end
    s_load_dwordx4 s[4:7], s[0:1], 8
    s_load_dwordx2 s[8:9], s[0:1], 32
    s_load_dwordx2 s[10:11], s[0:1], 104
    s_load_dwordx2 s[44:45], s[0:1], 0
    s_load_dwordx2 s[46:47], s[0:1], 72
    s_load_dwordx4 s[64:67], s[0:1], 56
    s_load_dwordx2 s[70:71], s[0:1], 40
    v_lshlrev_b32 v1, 4, v0
    v_lshlrev_b32 v2, 3, v0
    v_mov_b32 v104, 0
    v_mov_b32 v105, 0
    ds_write_b64 v2, v[104:105]
    ds_write_b64 v2, v[104:105] offset:12288
    v_lshrrev_b32 v3, 6, v0
    s_nop 0
    v_readfirstlane_b32 s33, v3
    s_bitcmp1_b32 s2, 0
    s_cselect_b32 s35, -24, 24
    s_cselect_b32 s36, 384, 0
    s_add_u32 s35, s35, 1000
    v_cmpx_gt_u32 vcc, s35, v0
    s_and_b32 s34, s2, 240
    s_mul_i32 s34, s34, 9
    s_add_u32 s34, s34, s2
    s_mul_i32 s34, s34, 16000
    s_add_u32 s34, s34, s36
    s_lshr_b32 s36, s34, 1
    s_waitcnt lgkmcnt(0)
    s_mov_b32 s16, s6
    s_and_b32 s17, s7, 0xffff
    s_mov_b32 s18, 40960000
    s_mov_b32 s19, 0x00020000
    s_mov_b32 s12, s4
    s_and_b32 s13, s5, 0xffff
    s_mov_b32 s14, 40960000
    s_mov_b32 s15, 0x00020000
    s_cmp_lg_u32 s33, 14
    s_cbranch_scc1 Lp_nopf
    s_getpc_b64 s[38:39]
Lp_here:
    s_and_b32 s40, s2, 0xf8
    s_lshl_b32 s40, s40, 8
    v_and_b32 v108, 63, v0
    v_lshl_add_u32 v110, v108, 7, s40
    v_cmpx_gt_u32 vcc, 16, v108
    v_cmpx_gt_u32 vcc, Lc_slow-Lp_here, v110
    s_cbranch_execz Lp_nopf2
    v_mov_b32 v109, s39
    v_add_co_u32 v108, vcc, s38, v110
    s_nop 1
    v_addc_co_u32 v109, vcc, 0, v109, vcc
    global_load_dword v119, v[108:109], off
Lp_nopf2:
    s_mov_b64 exec, -1
Lp_nopf:
    s_add_u32 s35, s34, 0
    buffer_load_dwordx4 v[4:7], v1, s[16:19], s35 offen nt
    s_add_u32 s35, s34, 0
    buffer_load_dwordx4 v[24:27], v1, s[12:15], s35 offen nt
    s_load_dwordx8 s[56:63], s[46:47], 0
    s_load_dwordx4 s[96:99], s[70:71], 0
    s_load_dword s72, s[66:67], 0
    s_load_dword s73, s[66:67], 64
    s_load_dword s74, s[66:67], 128
    s_load_dword s75, s[64:65], 0
    s_mov_b32 s48, s44
    s_and_b32 s49, s45, 0xffff
    s_mov_b32 s50, 2560000
    s_mov_b32 s51, 0x00020000
    s_min_u32 s45, s2, 249
    s_mul_i32 s41, s45, 10240
    s_add_u32 s42, s41, 7680
    buffer_load_dwordx2 v[104:105], v2, s[48:51], s41 offen
    s_cmp_ge_u32 s33, 5
    s_cselect_b32 s42, 2560000, s42
    buffer_load_dwordx2 v[106:107], v2, s[48:51], s42 offen
    s_add_u32 s35, s34, 256000
    buffer_load_dwordx4 v[8:11], v1, s[16:19], s35 offen nt
    s_add_u32 s35, s34, 256000
    buffer_load_dwordx4 v[28:31], v1, s[12:15], s35 offen nt
    s_mov_b32 s20, s8
    s_and_b32 s21, s9, 0xffff
    s_mov_b32 s22, 20480000
    s_mov_b32 s23, 0x00020000
    s_mov_b32 s28, s10
    s_and_b32 s29, s11, 0xffff
    s_mov_b32 s30, 12582912
    s_mov_b32 s31, 0x00020000
    s_mul_i32 s37, s2, 235520
    s_add_u32 s37, s37, 12582912
    s_add_u32 s24, s10, s37
    s_addc_u32 s25, s11, 0
    s_and_b32 s25, s25, 0xffff
    s_mov_b32 s27, 0x00020000
    s_mul_i32 s37, s2, 235520
    s_add_u32 s37, s37, 12700672
    s_add_u32 s52, s10, s37
    s_addc_u32 s53, s11, 0
    s_and_b32 s53, s53, 0xffff
    s_mov_b32 s55, 0x00020000
    s_mov_b32 s43, -191
    s_mov_b32 s44, -448
    s_mov_b32 s42, 2745
    s_waitcnt lgkmcnt(0)
    s_lshl_b32 s88, s96, 16
    s_and_b32 s89, s96, 0xffff0000
    s_lshl_b32 s90, s97, 16
    s_and_b32 s91, s97, 0xffff0000
    s_lshl_b32 s92, s98, 16
    s_and_b32 s93, s98, 0xffff0000
    s_lshl_b32 s94, s99, 16
    s_and_b32 s95, s99, 0xffff0000
    s_barrier
    s_setprio 3
    s_cmp_ge_u32 s33, 4
    s_cbranch_scc1 Lp_nog
    s_lshl_b32 s40, s2, 24
    v_lshl_add_u32 v78, v0, 16, s40
    s_load_dwordx8 s[72:79], s[66:67], 0
    s_load_dwordx4 s[80:83], s[66:67], 32
    s_load_dwordx4 s[84:87], s[64:65], 0
    v_subrev_f32 v76, s88, v78
    v_subrev_f32 v77, s89, v78
    v_cvt_pk_bf16_f32 v76, 0, v76
    v_cvt_pk_bf16_f32 v77, 0, v77
    v_mul_f32 v76, v76, v76
    v_mul_f32 v77, v77, v77
    v_cvt_pk_bf16_f32 v76, 0, v76
    v_cvt_pk_bf16_f32 v77, 0, v77
    v_mul_f32 v76, 0xc1200000, v76
    v_mul_f32 v77, 0xc1200000, v77
    v_cvt_pk_bf16_f32 v76, 0, v76
    v_cvt_pk_bf16_f32 v77, 0, v77
    v_mul_f32 v76, 0x3fb8aa3b, v76
    v_mul_f32 v77, 0x3fb8aa3b, v77
    v_exp_f32 v76, v76
    v_exp_f32 v77, v77
    s_nop 0
    v_cvt_pk_bf16_f32 v56, v76, v77
    v_subrev_f32 v76, s90, v78
    v_subrev_f32 v77, s91, v78
    v_cvt_pk_bf16_f32 v76, 0, v76
    v_cvt_pk_bf16_f32 v77, 0, v77
    v_mul_f32 v76, v76, v76
    v_mul_f32 v77, v77, v77
    v_cvt_pk_bf16_f32 v76, 0, v76
    v_cvt_pk_bf16_f32 v77, 0, v77
    v_mul_f32 v76, 0xc1200000, v76
    v_mul_f32 v77, 0xc1200000, v77
    v_cvt_pk_bf16_f32 v76, 0, v76
    v_cvt_pk_bf16_f32 v77, 0, v77
    v_mul_f32 v76, 0x3fb8aa3b, v76
    v_mul_f32 v77, 0x3fb8aa3b, v77
    v_exp_f32 v76, v76
    v_exp_f32 v77, v77
    s_nop 0
    v_cvt_pk_bf16_f32 v57, v76, v77
    v_subrev_f32 v76, s92, v78
    v_subrev_f32 v77, s93, v78
    v_cvt_pk_bf16_f32 v76, 0, v76
    v_cvt_pk_bf16_f32 v77, 0, v77
    v_mul_f32 v76, v76, v76
    v_mul_f32 v77, v77, v77
    v_cvt_pk_bf16_f32 v76, 0, v76
    v_cvt_pk_bf16_f32 v77, 0, v77
    v_mul_f32 v76, 0xc1200000, v76
    v_mul_f32 v77, 0xc1200000, v77
    v_cvt_pk_bf16_f32 v76, 0, v76
    v_cvt_pk_bf16_f32 v77, 0, v77
    v_mul_f32 v76, 0x3fb8aa3b, v76
    v_mul_f32 v77, 0x3fb8aa3b, v77
    v_exp_f32 v76, v76
    v_exp_f32 v77, v77
    s_nop 0
    v_cvt_pk_bf16_f32 v58, v76, v77
    v_subrev_f32 v76, s94, v78
    v_subrev_f32 v77, s95, v78
    v_cvt_pk_bf16_f32 v76, 0, v76
    v_cvt_pk_bf16_f32 v77, 0, v77
    v_mul_f32 v76, v76, v76
    v_mul_f32 v77, v77, v77
    v_cvt_pk_bf16_f32 v76, 0, v76
    v_cvt_pk_bf16_f32 v77, 0, v77
    v_mul_f32 v76, 0xc1200000, v76
    v_mul_f32 v77, 0xc1200000, v77
    v_cvt_pk_bf16_f32 v76, 0, v76
    v_cvt_pk_bf16_f32 v77, 0, v77
    v_mul_f32 v76, 0x3fb8aa3b, v76
    v_mul_f32 v77, 0x3fb8aa3b, v77
    v_exp_f32 v76, v76
    v_exp_f32 v77, v77
    s_nop 0
    v_cvt_pk_bf16_f32 v59, v76, v77
    s_waitcnt lgkmcnt(0)
    s_pack_ll_b32_b16 s40, s72, s78
    v_dot2_f32_bf16 v60, v56, s40, 0
    s_pack_hh_b32_b16 s40, s72, s78
    v_dot2_f32_bf16 v61, v56, s40, 0
    s_pack_ll_b32_b16 s40, s73, s79
    v_dot2_f32_bf16 v62, v56, s40, 0
    s_pack_hh_b32_b16 s40, s73, s79
    v_dot2_f32_bf16 v63, v56, s40, 0
    s_pack_ll_b32_b16 s40, s74, s80
    v_dot2_f32_bf16 v64, v56, s40, 0
    s_pack_hh_b32_b16 s40, s74, s80
    v_dot2_f32_bf16 v65, v56, s40, 0
    s_pack_ll_b32_b16 s40, s75, s81
    v_dot2_f32_bf16 v66, v56, s40, 0
    s_pack_hh_b32_b16 s40, s75, s81
    v_dot2_f32_bf16 v67, v56, s40, 0
    s_pack_ll_b32_b16 s40, s76, s82
    v_dot2_f32_bf16 v68, v56, s40, 0
    s_pack_hh_b32_b16 s40, s76, s82
    v_dot2_f32_bf16 v69, v56, s40, 0
    s_pack_ll_b32_b16 s40, s77, s83
    v_dot2_f32_bf16 v70, v56, s40, 0
    s_pack_hh_b32_b16 s40, s77, s83
    v_dot2_f32_bf16 v71, v56, s40, 0
    s_pack_ll_b32_b16 s40, s84, s86
    v_dot2_f32_bf16 v72, v56, s40, 0
    s_pack_hh_b32_b16 s40, s84, s86
    v_dot2_f32_bf16 v73, v56, s40, 0
    s_pack_ll_b32_b16 s40, s85, s87
    v_dot2_f32_bf16 v74, v56, s40, 0
    s_pack_hh_b32_b16 s40, s85, s87
    v_dot2_f32_bf16 v75, v56, s40, 0
    s_load_dwordx8 s[72:79], s[66:67], 48
    s_load_dwordx4 s[80:83], s[66:67], 80
    s_load_dwordx4 s[84:87], s[64:65], 16
    s_waitcnt lgkmcnt(0)
    s_pack_ll_b32_b16 s40, s72, s78
    v_dot2_f32_bf16 v60, v57, s40, v60
    s_pack_hh_b32_b16 s40, s72, s78
    v_dot2_f32_bf16 v61, v57, s40, v61
    s_pack_ll_b32_b16 s40, s73, s79
    v_dot2_f32_bf16 v62, v57, s40, v62
    s_pack_hh_b32_b16 s40, s73, s79
    v_dot2_f32_bf16 v63, v57, s40, v63
    s_pack_ll_b32_b16 s40, s74, s80
    v_dot2_f32_bf16 v64, v57, s40, v64
    s_pack_hh_b32_b16 s40, s74, s80
    v_dot2_f32_bf16 v65, v57, s40, v65
    s_pack_ll_b32_b16 s40, s75, s81
    v_dot2_f32_bf16 v66, v57, s40, v66
    s_pack_hh_b32_b16 s40, s75, s81
    v_dot2_f32_bf16 v67, v57, s40, v67
    s_pack_ll_b32_b16 s40, s76, s82
    v_dot2_f32_bf16 v68, v57, s40, v68
    s_pack_hh_b32_b16 s40, s76, s82
    v_dot2_f32_bf16 v69, v57, s40, v69
    s_pack_ll_b32_b16 s40, s77, s83
    v_dot2_f32_bf16 v70, v57, s40, v70
    s_pack_hh_b32_b16 s40, s77, s83
    v_dot2_f32_bf16 v71, v57, s40, v71
    s_pack_ll_b32_b16 s40, s84, s86
    v_dot2_f32_bf16 v72, v57, s40, v72
    s_pack_hh_b32_b16 s40, s84, s86
    v_dot2_f32_bf16 v73, v57, s40, v73
    s_pack_ll_b32_b16 s40, s85, s87
    v_dot2_f32_bf16 v74, v57, s40, v74
    s_pack_hh_b32_b16 s40, s85, s87
    v_dot2_f32_bf16 v75, v57, s40, v75
    s_load_dwordx8 s[72:79], s[66:67], 96
    s_load_dwordx4 s[80:83], s[66:67], 128
    s_load_dwordx4 s[84:87], s[64:65], 32
    s_waitcnt lgkmcnt(0)
    s_pack_ll_b32_b16 s40, s72, s78
    v_dot2_f32_bf16 v60, v58, s40, v60
    s_pack_hh_b32_b16 s40, s72, s78
    v_dot2_f32_bf16 v61, v58, s40, v61
    s_pack_ll_b32_b16 s40, s73, s79
    v_dot2_f32_bf16 v62, v58, s40, v62
    s_pack_hh_b32_b16 s40, s73, s79
    v_dot2_f32_bf16 v63, v58, s40, v63
    s_pack_ll_b32_b16 s40, s74, s80
    v_dot2_f32_bf16 v64, v58, s40, v64
    s_pack_hh_b32_b16 s40, s74, s80
    v_dot2_f32_bf16 v65, v58, s40, v65
    s_pack_ll_b32_b16 s40, s75, s81
    v_dot2_f32_bf16 v66, v58, s40, v66
    s_pack_hh_b32_b16 s40, s75, s81
    v_dot2_f32_bf16 v67, v58, s40, v67
    s_pack_ll_b32_b16 s40, s76, s82
    v_dot2_f32_bf16 v68, v58, s40, v68
    s_pack_hh_b32_b16 s40, s76, s82
    v_dot2_f32_bf16 v69, v58, s40, v69
    s_pack_ll_b32_b16 s40, s77, s83
    v_dot2_f32_bf16 v70, v58, s40, v70
    s_pack_hh_b32_b16 s40, s77, s83
    v_dot2_f32_bf16 v71, v58, s40, v71
    s_pack_ll_b32_b16 s40, s84, s86
    v_dot2_f32_bf16 v72, v58, s40, v72
    s_pack_hh_b32_b16 s40, s84, s86
    v_dot2_f32_bf16 v73, v58, s40, v73
    s_pack_ll_b32_b16 s40, s85, s87
    v_dot2_f32_bf16 v74, v58, s40, v74
    s_pack_hh_b32_b16 s40, s85, s87
    v_dot2_f32_bf16 v75, v58, s40, v75
    s_load_dwordx8 s[72:79], s[66:67], 144
    s_load_dwordx4 s[80:83], s[66:67], 176
    s_load_dwordx4 s[84:87], s[64:65], 48
    s_waitcnt lgkmcnt(0)
    s_pack_ll_b32_b16 s40, s72, s78
    v_dot2_f32_bf16 v60, v59, s40, v60
    s_pack_hh_b32_b16 s40, s72, s78
    v_dot2_f32_bf16 v61, v59, s40, v61
    s_pack_ll_b32_b16 s40, s73, s79
    v_dot2_f32_bf16 v62, v59, s40, v62
    s_pack_hh_b32_b16 s40, s73, s79
    v_dot2_f32_bf16 v63, v59, s40, v63
    s_pack_ll_b32_b16 s40, s74, s80
    v_dot2_f32_bf16 v64, v59, s40, v64
    s_pack_hh_b32_b16 s40, s74, s80
    v_dot2_f32_bf16 v65, v59, s40, v65
    s_pack_ll_b32_b16 s40, s75, s81
    v_dot2_f32_bf16 v66, v59, s40, v66
    s_pack_hh_b32_b16 s40, s75, s81
    v_dot2_f32_bf16 v67, v59, s40, v67
    s_pack_ll_b32_b16 s40, s76, s82
    v_dot2_f32_bf16 v68, v59, s40, v68
    s_pack_hh_b32_b16 s40, s76, s82
    v_dot2_f32_bf16 v69, v59, s40, v69
    s_pack_ll_b32_b16 s40, s77, s83
    v_dot2_f32_bf16 v70, v59, s40, v70
    s_pack_hh_b32_b16 s40, s77, s83
    v_dot2_f32_bf16 v71, v59, s40, v71
    s_pack_ll_b32_b16 s40, s84, s86
    v_dot2_f32_bf16 v72, v59, s40, v72
    s_pack_hh_b32_b16 s40, s84, s86
    v_dot2_f32_bf16 v73, v59, s40, v73
    s_pack_ll_b32_b16 s40, s85, s87
    v_dot2_f32_bf16 v74, v59, s40, v74
    s_pack_hh_b32_b16 s40, s85, s87
    v_dot2_f32_bf16 v75, v59, s40, v75
    v_add_f32 v56, |v60|, |v64|
    v_add_f32 v57, |v61|, |v65|
    v_add_f32 v58, |v62|, |v66|
    v_add_f32 v59, |v63|, |v67|
    v_add_f32 v56, v56, |v68|
    v_add_f32 v57, v57, |v69|
    v_add_f32 v58, v58, |v70|
    v_add_f32 v59, v59, |v71|
    v_cvt_pk_bf16_f32 v72, 0, v72
    v_cvt_pk_bf16_f32 v73, 0, v73
    v_cvt_pk_bf16_f32 v74, 0, v74
    v_cvt_pk_bf16_f32 v75, 0, v75
    v_max3_f32 v56, v56, v57, v58
    v_max_f32 v56, v56, v59
    v_mul_f32 v56, 0x3f83d70a, v56
    v_frexp_exp_i32_f32 v59, v56
    v_sub_u32 v76, 0, v59
    v_ldexp_f32 v72, v72, v59
    v_ldexp_f32 v73, v73, v59
    v_ldexp_f32 v74, v74, v59
    v_ldexp_f32 v75, v75, v59
    v_ldexp_f32 v60, v60, v76
    v_mul_f32 v60, 0x30001002, v60
    v_ldexp_f32 v61, v61, v76
    v_mul_f32 v61, 0x30001002, v61
    v_ldexp_f32 v62, v62, v76
    v_mul_f32 v62, 0x30001002, v62
    v_ldexp_f32 v63, v63, v76
    v_mul_f32 v63, 0x30001002, v63
    v_ldexp_f32 v64, v64, v76
    v_mul_f32 v64, 0x21002006, v64
    v_ldexp_f32 v65, v65, v76
    v_mul_f32 v65, 0x21002006, v65
    v_ldexp_f32 v66, v66, v76
    v_mul_f32 v66, 0x21002006, v66
    v_ldexp_f32 v67, v67, v76
    v_mul_f32 v67, 0x21002006, v67
    v_ldexp_f32 v68, v68, v76
    v_mul_f32 v68, 0x3f800000, v68
    v_ldexp_f32 v69, v69, v76
    v_mul_f32 v69, 0x3f800000, v69
    v_ldexp_f32 v70, v70, v76
    v_mul_f32 v70, 0x3f800000, v70
    v_ldexp_f32 v71, v71, v76
    v_mul_f32 v71, 0x3f800000, v71
    v_cvt_pk_bf16_f32 v60, v60, v64
    v_cvt_pk_bf16_f32 v61, v61, v65
    v_cvt_pk_bf16_f32 v62, v62, v66
    v_cvt_pk_bf16_f32 v63, v63, v67
    v_cvt_pk_bf16_f32 v66, v72, v73
    v_cvt_pk_bf16_f32 v67, v74, v75
    v_cvt_f16_f32 v76, v68
    v_and_b32 v76, 0xffff, v76
    v_and_b32 v77, 0x7fffffff, v69
    v_add_u32 v77, 0x8000, v77
    v_sub_u32 v77, v77, v76
    v_max_i32 v77, 0, v77
    v_and_b32 v77, 0x7fff0000, v77
    v_or_b32 v76, v76, v77
    v_and_b32 v77, 0x80000000, v69
    v_or_b32 v64, v76, v77
    v_cvt_f16_f32 v76, v70
    v_and_b32 v76, 0xffff, v76
    v_and_b32 v77, 0x7fffffff, v71
    v_add_u32 v77, 0x8000, v77
    v_sub_u32 v77, v77, v76
    v_max_i32 v77, 0, v77
    v_and_b32 v77, 0x7fff0000, v77
    v_or_b32 v76, v76, v77
    v_and_b32 v77, 0x80000000, v71
    v_or_b32 v65, v76, v77
    s_lshl_b32 s40, s2, 13
    s_add_u32 s41, s40, 8388608
    v_lshlrev_b32 v76, 5, v0
    ds_write_b128 v76, v[60:63] offset:12320
    ds_write_b128 v76, v[64:67] offset:12336
    s_lshl_b32 s40, s33, 10
    v_add_u32 v76, s40, v1
    ds_read_b128 v[68:71], v76 offset:12320
    ds_read_b128 v[72:75], v76 offset:13344
    s_waitcnt lgkmcnt(0)
    buffer_store_dwordx4 v[68:71], v76, s[28:31], s41 offen sc1
    buffer_store_dwordx4 v[72:75], v76, s[28:31], s41 offen offset:1024 sc1
Lp_nog:
    s_add_u32 s35, s34, 512000
    buffer_load_dwordx4 v[12:15], v1, s[16:19], s35 offen nt
    s_add_u32 s35, s34, 512000
    buffer_load_dwordx4 v[32:35], v1, s[12:15], s35 offen nt
    s_waitcnt vmcnt(4)
    s_cmp_eq_u32 s33, 15
    s_cbranch_scc1 Lp_nomd
    s_pack_ll_b32_b16 s40, s56, s58
    v_dot2_f32_bf16 v108, v104, s40, 0
    s_pack_hh_b32_b16 s40, s56, s58
    v_dot2_f32_bf16 v109, v104, s40, 0
    s_pack_ll_b32_b16 s40, s57, s59
    v_dot2_f32_bf16 v110, v104, s40, 0
    s_pack_hh_b32_b16 s40, s57, s59
    v_dot2_f32_bf16 v111, v104, s40, 0
    s_pack_ll_b32_b16 s40, s60, s62
    v_dot2_f32_bf16 v108, v105, s40, v108
    s_pack_hh_b32_b16 s40, s60, s62
    v_dot2_f32_bf16 v109, v105, s40, v109
    s_pack_ll_b32_b16 s40, s61, s63
    v_dot2_f32_bf16 v110, v105, s40, v110
    s_pack_hh_b32_b16 s40, s61, s63
    v_dot2_f32_bf16 v111, v105, s40, v111
    s_mul_i32 s40, s45, 1280
    s_add_u32 s40, s40, 0
    v_add_u32 v114, s40, v0
    v_max3_f32 v115, |v108|, |v109|, |v110|
    v_max_f32 v115, v115, |v111|
    v_mov_b32 v116, 12296
    ds_max_u32 v116, v115
    v_cvt_pk_bf16_f32 v112, v108, 0
    v_and_b32 v113, 0x7fffffff, v109
    v_add_u32 v113, 0x8000, v113
    v_sub_u32 v113, v113, v112
    v_max_i32 v113, 0, v113
    v_and_b32 v113, 0x7fff0000, v113
    v_or_b32 v112, v112, v113
    v_and_b32 v113, 0x80000000, v109
    v_or_b32 v104, v112, v113
    v_cvt_pk_bf16_f32 v112, v110, 0
    v_and_b32 v113, 0x7fffffff, v111
    v_add_u32 v113, 0x8000, v113
    v_sub_u32 v113, v113, v112
    v_max_i32 v113, 0, v113
    v_and_b32 v113, 0x7fff0000, v113
    v_or_b32 v112, v112, v113
    v_and_b32 v113, 0x80000000, v111
    v_or_b32 v105, v112, v113
    v_lshlrev_b32 v114, 3, v114
    s_mov_b32 s40, 3321344
    buffer_store_dwordx2 v[104:105], v114, s[28:31], s40 offen sc1
    s_cmp_ge_u32 s33, 5
    s_cbranch_scc1 Lp_nomd
    s_pack_ll_b32_b16 s40, s56, s58
    v_dot2_f32_bf16 v108, v106, s40, 0
    s_pack_hh_b32_b16 s40, s56, s58
    v_dot2_f32_bf16 v109, v106, s40, 0
    s_pack_ll_b32_b16 s40, s57, s59
    v_dot2_f32_bf16 v110, v106, s40, 0
    s_pack_hh_b32_b16 s40, s57, s59
    v_dot2_f32_bf16 v111, v106, s40, 0
    s_pack_ll_b32_b16 s40, s60, s62
    v_dot2_f32_bf16 v108, v107, s40, v108
    s_pack_hh_b32_b16 s40, s60, s62
    v_dot2_f32_bf16 v109, v107, s40, v109
    s_pack_ll_b32_b16 s40, s61, s63
    v_dot2_f32_bf16 v110, v107, s40, v110
    s_pack_hh_b32_b16 s40, s61, s63
    v_dot2_f32_bf16 v111, v107, s40, v111
    s_mul_i32 s40, s45, 1280
    s_add_u32 s40, s40, 960
    v_add_u32 v114, s40, v0
    v_max3_f32 v115, |v108|, |v109|, |v110|
    v_max_f32 v115, v115, |v111|
    v_mov_b32 v116, 12296
    ds_max_u32 v116, v115
    v_cvt_pk_bf16_f32 v112, v108, 0
    v_and_b32 v113, 0x7fffffff, v109
    v_add_u32 v113, 0x8000, v113
    v_sub_u32 v113, v113, v112
    v_max_i32 v113, 0, v113
    v_and_b32 v113, 0x7fff0000, v113
    v_or_b32 v112, v112, v113
    v_and_b32 v113, 0x80000000, v109
    v_or_b32 v106, v112, v113
    v_cvt_pk_bf16_f32 v112, v110, 0
    v_and_b32 v113, 0x7fffffff, v111
    v_add_u32 v113, 0x8000, v113
    v_sub_u32 v113, v113, v112
    v_max_i32 v113, 0, v113
    v_and_b32 v113, 0x7fff0000, v113
    v_or_b32 v112, v112, v113
    v_and_b32 v113, 0x80000000, v111
    v_or_b32 v107, v112, v113
    v_lshlrev_b32 v114, 3, v114
    s_mov_b32 s40, 3321344
    buffer_store_dwordx2 v[106:107], v114, s[28:31], s40 offen sc1
Lp_nomd:
    s_waitcnt vmcnt(6)
    v_mov_b32 v3, 1
    v_mov_b32 v122, 131760
    v_mul_hi_u32_u24 v125, 9586981, v24
    v_mul_hi_u32_u24 v104, 3435974, v4
    v_mad_u32_u24 v120, v125, s42, v122
    v_mul_u32_u24 v124, 1250, v104
    v_mad_i32_i24 v24, v125, s44, v24
    v_and_b32 v124, -16, v124
    v_bfe_u32 v120, v120, 19, 2
    v_sub_u32 v124, v4, v124
    v_lshl_or_b32 v104, v120, 8, v104
    v_lshl_or_b32 v24, v124, 9, v24
    v_mad_i32_i24 v125, v120, s43, v125
    v_lshlrev_b32 v4, 2, v104
    v_lshl_or_b32 v24, v125, 20, v24
    ds_add_u32 v4, v3 offset:0
    v_mul_hi_u32_u24 v127, 9586981, v25
    v_mul_hi_u32_u24 v105, 3435974, v5
    v_mad_u32_u24 v121, v127, s42, v122
    v_mul_u32_u24 v126, 1250, v105
    v_mad_i32_i24 v25, v127, s44, v25
    v_and_b32 v126, -16, v126
    v_bfe_u32 v121, v121, 19, 2
    v_sub_u32 v126, v5, v126
    v_lshl_or_b32 v105, v121, 8, v105
    v_lshl_or_b32 v25, v126, 9, v25
    v_mad_i32_i24 v127, v121, s43, v127
    v_lshlrev_b32 v5, 2, v105
    v_lshl_or_b32 v25, v127, 20, v25
    ds_add_u32 v5, v3 offset:0
    v_mul_hi_u32_u24 v125, 9586981, v26
    v_mul_hi_u32_u24 v104, 3435974, v6
    v_mad_u32_u24 v120, v125, s42, v122
    v_mul_u32_u24 v124, 1250, v104
    v_mad_i32_i24 v26, v125, s44, v26
    v_and_b32 v124, -16, v124
    v_bfe_u32 v120, v120, 19, 2
    v_sub_u32 v124, v6, v124
    v_lshl_or_b32 v104, v120, 8, v104
    v_lshl_or_b32 v26, v124, 9, v26
    v_mad_i32_i24 v125, v120, s43, v125
    v_lshlrev_b32 v6, 2, v104
    v_lshl_or_b32 v26, v125, 20, v26
    ds_add_u32 v6, v3 offset:0
    v_mul_hi_u32_u24 v127, 9586981, v27
    v_mul_hi_u32_u24 v105, 3435974, v7
    v_mad_u32_u24 v121, v127, s42, v122
    v_mul_u32_u24 v126, 1250, v105
    v_mad_i32_i24 v27, v127, s44, v27
    v_and_b32 v126, -16, v126
    v_bfe_u32 v121, v121, 19, 2
    v_sub_u32 v126, v7, v126
    v_lshl_or_b32 v105, v121, 8, v105
    v_lshl_or_b32 v27, v126, 9, v27
    v_mad_i32_i24 v127, v121, s43, v127
    v_lshlrev_b32 v7, 2, v105
    v_lshl_or_b32 v27, v127, 20, v27
    ds_add_u32 v7, v3 offset:0
    s_setprio 2
    s_add_u32 s35, s34, 768000
    buffer_load_dwordx4 v[16:19], v1, s[16:19], s35 offen nt
    s_add_u32 s35, s34, 768000
    buffer_load_dwordx4 v[36:39], v1, s[12:15], s35 offen nt
    s_waitcnt vmcnt(4)
    v_mov_b32 v3, 1
    v_mov_b32 v122, 131760
    v_mul_hi_u32_u24 v125, 9586981, v28
    v_mul_hi_u32_u24 v104, 3435974, v8
    v_mad_u32_u24 v120, v125, s42, v122
    v_mul_u32_u24 v124, 1250, v104
    v_mad_i32_i24 v28, v125, s44, v28
    v_and_b32 v124, -16, v124
    v_bfe_u32 v120, v120, 19, 2
    v_sub_u32 v124, v8, v124
    v_lshl_or_b32 v104, v120, 8, v104
    v_lshl_or_b32 v28, v124, 9, v28
    v_mad_i32_i24 v125, v120, s43, v125
    v_lshlrev_b32 v8, 2, v104
    v_lshl_or_b32 v28, v125, 20, v28
    ds_add_u32 v8, v3 offset:0
    v_mul_hi_u32_u24 v127, 9586981, v29
    v_mul_hi_u32_u24 v105, 3435974, v9
    v_mad_u32_u24 v121, v127, s42, v122
    v_mul_u32_u24 v126, 1250, v105
    v_mad_i32_i24 v29, v127, s44, v29
    v_and_b32 v126, -16, v126
    v_bfe_u32 v121, v121, 19, 2
    v_sub_u32 v126, v9, v126
    v_lshl_or_b32 v105, v121, 8, v105
    v_lshl_or_b32 v29, v126, 9, v29
    v_mad_i32_i24 v127, v121, s43, v127
    v_lshlrev_b32 v9, 2, v105
    v_lshl_or_b32 v29, v127, 20, v29
    ds_add_u32 v9, v3 offset:0
    v_mul_hi_u32_u24 v125, 9586981, v30
    v_mul_hi_u32_u24 v104, 3435974, v10
    v_mad_u32_u24 v120, v125, s42, v122
    v_mul_u32_u24 v124, 1250, v104
    v_mad_i32_i24 v30, v125, s44, v30
    v_and_b32 v124, -16, v124
    v_bfe_u32 v120, v120, 19, 2
    v_sub_u32 v124, v10, v124
    v_lshl_or_b32 v104, v120, 8, v104
    v_lshl_or_b32 v30, v124, 9, v30
    v_mad_i32_i24 v125, v120, s43, v125
    v_lshlrev_b32 v10, 2, v104
    v_lshl_or_b32 v30, v125, 20, v30
    ds_add_u32 v10, v3 offset:0
    v_mul_hi_u32_u24 v127, 9586981, v31
    v_mul_hi_u32_u24 v105, 3435974, v11
    v_mad_u32_u24 v121, v127, s42, v122
    v_mul_u32_u24 v126, 1250, v105
    v_mad_i32_i24 v31, v127, s44, v31
    v_and_b32 v126, -16, v126
    v_bfe_u32 v121, v121, 19, 2
    v_sub_u32 v126, v11, v126
    v_lshl_or_b32 v105, v121, 8, v105
    v_lshl_or_b32 v31, v126, 9, v31
    v_mad_i32_i24 v127, v121, s43, v127
    v_lshlrev_b32 v11, 2, v105
    v_lshl_or_b32 v31, v127, 20, v31
    ds_add_u32 v11, v3 offset:0
    s_setprio 1
    s_add_u32 s35, s34, 1024000
    buffer_load_dwordx4 v[20:23], v1, s[16:19], s35 offen nt
    s_add_u32 s35, s34, 1024000
    buffer_load_dwordx4 v[40:43], v1, s[12:15], s35 offen nt
    s_waitcnt vmcnt(4)
    v_mov_b32 v3, 1
    v_mov_b32 v122, 131760
    v_mul_hi_u32_u24 v125, 9586981, v32
    v_mul_hi_u32_u24 v104, 3435974, v12
    v_mad_u32_u24 v120, v125, s42, v122
    v_mul_u32_u24 v124, 1250, v104
    v_mad_i32_i24 v32, v125, s44, v32
    v_and_b32 v124, -16, v124
    v_bfe_u32 v120, v120, 19, 2
    v_sub_u32 v124, v12, v124
    v_lshl_or_b32 v104, v120, 8, v104
    v_lshl_or_b32 v32, v124, 9, v32
    v_mad_i32_i24 v125, v120, s43, v125
    v_lshlrev_b32 v12, 2, v104
    v_lshl_or_b32 v32, v125, 20, v32
    ds_add_u32 v12, v3 offset:0
    v_mul_hi_u32_u24 v127, 9586981, v33
    v_mul_hi_u32_u24 v105, 3435974, v13
    v_mad_u32_u24 v121, v127, s42, v122
    v_mul_u32_u24 v126, 1250, v105
    v_mad_i32_i24 v33, v127, s44, v33
    v_and_b32 v126, -16, v126
    v_bfe_u32 v121, v121, 19, 2
    v_sub_u32 v126, v13, v126
    v_lshl_or_b32 v105, v121, 8, v105
    v_lshl_or_b32 v33, v126, 9, v33
    v_mad_i32_i24 v127, v121, s43, v127
    v_lshlrev_b32 v13, 2, v105
    v_lshl_or_b32 v33, v127, 20, v33
    ds_add_u32 v13, v3 offset:0
    v_mul_hi_u32_u24 v125, 9586981, v34
    v_mul_hi_u32_u24 v104, 3435974, v14
    v_mad_u32_u24 v120, v125, s42, v122
    v_mul_u32_u24 v124, 1250, v104
    v_mad_i32_i24 v34, v125, s44, v34
    v_and_b32 v124, -16, v124
    v_bfe_u32 v120, v120, 19, 2
    v_sub_u32 v124, v14, v124
    v_lshl_or_b32 v104, v120, 8, v104
    v_lshl_or_b32 v34, v124, 9, v34
    v_mad_i32_i24 v125, v120, s43, v125
    v_lshlrev_b32 v14, 2, v104
    v_lshl_or_b32 v34, v125, 20, v34
    ds_add_u32 v14, v3 offset:0
    v_mul_hi_u32_u24 v127, 9586981, v35
    v_mul_hi_u32_u24 v105, 3435974, v15
    v_mad_u32_u24 v121, v127, s42, v122
    v_mul_u32_u24 v126, 1250, v105
    v_mad_i32_i24 v35, v127, s44, v35
    v_and_b32 v126, -16, v126
    v_bfe_u32 v121, v121, 19, 2
    v_sub_u32 v126, v15, v126
    v_lshl_or_b32 v105, v121, 8, v105
    v_lshl_or_b32 v35, v126, 9, v35
    v_mad_i32_i24 v127, v121, s43, v127
    v_lshlrev_b32 v15, 2, v105
    v_lshl_or_b32 v35, v127, 20, v35
    ds_add_u32 v15, v3 offset:0
    s_setprio 0
    s_add_u32 s35, s36, 0
    buffer_load_dwordx2 v[44:45], v2, s[20:23], s35 offen nt
    s_add_u32 s35, s36, 128000
    buffer_load_dwordx2 v[46:47], v2, s[20:23], s35 offen nt
    s_waitcnt vmcnt(4)
    v_mov_b32 v3, 1
    v_mov_b32 v122, 131760
    v_mul_hi_u32_u24 v125, 9586981, v36
    v_mul_hi_u32_u24 v104, 3435974, v16
    v_mad_u32_u24 v120, v125, s42, v122
    v_mul_u32_u24 v124, 1250, v104
    v_mad_i32_i24 v36, v125, s44, v36
    v_and_b32 v124, -16, v124
    v_bfe_u32 v120, v120, 19, 2
    v_sub_u32 v124, v16, v124
    v_lshl_or_b32 v104, v120, 8, v104
    v_lshl_or_b32 v36, v124, 9, v36
    v_mad_i32_i24 v125, v120, s43, v125
    v_lshlrev_b32 v16, 2, v104
    v_lshl_or_b32 v36, v125, 20, v36
    ds_add_u32 v16, v3 offset:0
    v_mul_hi_u32_u24 v127, 9586981, v37
    v_mul_hi_u32_u24 v105, 3435974, v17
    v_mad_u32_u24 v121, v127, s42, v122
    v_mul_u32_u24 v126, 1250, v105
    v_mad_i32_i24 v37, v127, s44, v37
    v_and_b32 v126, -16, v126
    v_bfe_u32 v121, v121, 19, 2
    v_sub_u32 v126, v17, v126
    v_lshl_or_b32 v105, v121, 8, v105
    v_lshl_or_b32 v37, v126, 9, v37
    v_mad_i32_i24 v127, v121, s43, v127
    v_lshlrev_b32 v17, 2, v105
    v_lshl_or_b32 v37, v127, 20, v37
    ds_add_u32 v17, v3 offset:0
    v_mul_hi_u32_u24 v125, 9586981, v38
    v_mul_hi_u32_u24 v104, 3435974, v18
    v_mad_u32_u24 v120, v125, s42, v122
    v_mul_u32_u24 v124, 1250, v104
    v_mad_i32_i24 v38, v125, s44, v38
    v_and_b32 v124, -16, v124
    v_bfe_u32 v120, v120, 19, 2
    v_sub_u32 v124, v18, v124
    v_lshl_or_b32 v104, v120, 8, v104
    v_lshl_or_b32 v38, v124, 9, v38
    v_mad_i32_i24 v125, v120, s43, v125
    v_lshlrev_b32 v18, 2, v104
    v_lshl_or_b32 v38, v125, 20, v38
    ds_add_u32 v18, v3 offset:0
    v_mul_hi_u32_u24 v127, 9586981, v39
    v_mul_hi_u32_u24 v105, 3435974, v19
    v_mad_u32_u24 v121, v127, s42, v122
    v_mul_u32_u24 v126, 1250, v105
    v_mad_i32_i24 v39, v127, s44, v39
    v_and_b32 v126, -16, v126
    v_bfe_u32 v121, v121, 19, 2
    v_sub_u32 v126, v19, v126
    v_lshl_or_b32 v105, v121, 8, v105
    v_lshl_or_b32 v39, v126, 9, v39
    v_mad_i32_i24 v127, v121, s43, v127
    v_lshlrev_b32 v19, 2, v105
    v_lshl_or_b32 v39, v127, 20, v39
    ds_add_u32 v19, v3 offset:0
    s_add_u32 s35, s36, 256000
    buffer_load_dwordx2 v[48:49], v2, s[20:23], s35 offen nt
    s_add_u32 s35, s36, 384000
    buffer_load_dwordx2 v[50:51], v2, s[20:23], s35 offen nt
    s_waitcnt vmcnt(4)
    v_mov_b32 v3, 1
    v_mov_b32 v122, 131760
    v_mul_hi_u32_u24 v125, 9586981, v40
    v_mul_hi_u32_u24 v104, 3435974, v20
    v_mad_u32_u24 v120, v125, s42, v122
    v_mul_u32_u24 v124, 1250, v104
    v_mad_i32_i24 v40, v125, s44, v40
    v_and_b32 v124, -16, v124
    v_bfe_u32 v120, v120, 19, 2
    v_sub_u32 v124, v20, v124
    v_lshl_or_b32 v104, v120, 8, v104
    v_lshl_or_b32 v40, v124, 9, v40
    v_mad_i32_i24 v125, v120, s43, v125
    v_lshlrev_b32 v20, 2, v104
    v_lshl_or_b32 v40, v125, 20, v40
    ds_add_u32 v20, v3 offset:0
    v_mul_hi_u32_u24 v127, 9586981, v41
    v_mul_hi_u32_u24 v105, 3435974, v21
    v_mad_u32_u24 v121, v127, s42, v122
    v_mul_u32_u24 v126, 1250, v105
    v_mad_i32_i24 v41, v127, s44, v41
    v_and_b32 v126, -16, v126
    v_bfe_u32 v121, v121, 19, 2
    v_sub_u32 v126, v21, v126
    v_lshl_or_b32 v105, v121, 8, v105
    v_lshl_or_b32 v41, v126, 9, v41
    v_mad_i32_i24 v127, v121, s43, v127
    v_lshlrev_b32 v21, 2, v105
    v_lshl_or_b32 v41, v127, 20, v41
    ds_add_u32 v21, v3 offset:0
    v_mul_hi_u32_u24 v125, 9586981, v42
    v_mul_hi_u32_u24 v104, 3435974, v22
    v_mad_u32_u24 v120, v125, s42, v122
    v_mul_u32_u24 v124, 1250, v104
    v_mad_i32_i24 v42, v125, s44, v42
    v_and_b32 v124, -16, v124
    v_bfe_u32 v120, v120, 19, 2
    v_sub_u32 v124, v22, v124
    v_lshl_or_b32 v104, v120, 8, v104
    v_lshl_or_b32 v42, v124, 9, v42
    v_mad_i32_i24 v125, v120, s43, v125
    v_lshlrev_b32 v22, 2, v104
    v_lshl_or_b32 v42, v125, 20, v42
    ds_add_u32 v22, v3 offset:0
    v_mul_hi_u32_u24 v127, 9586981, v43
    v_mul_hi_u32_u24 v105, 3435974, v23
    v_mad_u32_u24 v121, v127, s42, v122
    v_mul_u32_u24 v126, 1250, v105
    v_mad_i32_i24 v43, v127, s44, v43
    v_and_b32 v126, -16, v126
    v_bfe_u32 v121, v121, 19, 2
    v_sub_u32 v126, v23, v126
    v_lshl_or_b32 v105, v121, 8, v105
    v_lshl_or_b32 v43, v126, 9, v43
    v_mad_i32_i24 v127, v121, s43, v127
    v_lshlrev_b32 v23, 2, v105
    v_lshl_or_b32 v43, v127, 20, v43
    ds_add_u32 v23, v3 offset:0
    s_add_u32 s35, s36, 512000
    buffer_load_dwordx2 v[52:53], v2, s[20:23], s35 offen nt
    s_waitcnt lgkmcnt(0)
    s_barrier
    s_cmp_ge_u32 s33, 4
    s_cbranch_scc1 Lp_skipB0
    s_setprio 3
    v_and_b32 v120, 0x3f0, v1
    ds_read_b128 v[104:107], v1 offset:0
    ds_read_b128 v[108:111], v120 offset:0
    ds_read_b128 v[112:115], v120 offset:1024
    ds_read_b128 v[116:119], v120 offset:2048
    v_mov_b32 v123, 0
    s_cmp_gt_u32 s33, 0
    s_cselect_b32 s37, -1, 0
    s_cmp_gt_u32 s33, 1
    s_cselect_b32 s38, -1, 0
    s_cmp_gt_u32 s33, 2
    s_cselect_b32 s39, -1, 0
    s_waitcnt lgkmcnt(0)
    v_add_u32 v104, 3, v104
    v_add_u32 v105, 3, v105
    v_add_u32 v106, 3, v106
    v_add_u32 v107, 3, v107
    v_add_u32 v108, 3, v108
    v_add_u32 v109, 3, v109
    v_add_u32 v110, 3, v110
    v_add_u32 v111, 3, v111
    v_add_u32 v112, 3, v112
    v_add_u32 v113, 3, v113
    v_add_u32 v114, 3, v114
    v_add_u32 v115, 3, v115
    v_add_u32 v116, 3, v116
    v_add_u32 v117, 3, v117
    v_add_u32 v118, 3, v118
    v_add_u32 v119, 3, v119
    v_lshrrev_b32 v104, 2, v104
    v_lshrrev_b32 v105, 2, v105
    v_lshrrev_b32 v106, 2, v106
    v_lshrrev_b32 v107, 2, v107
    v_lshrrev_b32 v108, 2, v108
    v_lshrrev_b32 v109, 2, v109
    v_lshrrev_b32 v110, 2, v110
    v_lshrrev_b32 v111, 2, v111
    v_lshrrev_b32 v112, 2, v112
    v_lshrrev_b32 v113, 2, v113
    v_lshrrev_b32 v114, 2, v114
    v_lshrrev_b32 v115, 2, v115
    v_lshrrev_b32 v116, 2, v116
    v_lshrrev_b32 v117, 2, v117
    v_lshrrev_b32 v118, 2, v118
    v_lshrrev_b32 v119, 2, v119
    v_add3_u32 v108, v108, v109, v110
    v_add_u32 v108, v108, v111
    v_and_b32 v108, s37, v108
    v_add3_u32 v112, v112, v113, v114
    v_add_u32 v112, v112, v115
    v_and_b32 v112, s38, v112
    v_add3_u32 v116, v116, v117, v118
    v_add_u32 v116, v116, v119
    v_and_b32 v116, s39, v116
    v_add3_u32 v121, v108, v112, v116
    v_mov_b32 v108, v104
    v_add_u32 v109, v108, v105
    v_add_u32 v110, v109, v106
    v_add_u32 v111, v110, v107
    v_lshl_or_b32 v121, v121, 16, v111
    s_nop 1
    v_add_u32_dpp v121, v121, v121 row_shr:1 row_mask:0xf bank_mask:0xf bound_ctrl:0
    s_nop 1
    v_add_u32_dpp v121, v121, v121 row_shr:2 row_mask:0xf bank_mask:0xf bound_ctrl:0
    s_nop 1
    v_add_u32_dpp v121, v121, v121 row_shr:4 row_mask:0xf bank_mask:0xf bound_ctrl:0
    s_nop 1
    v_add_u32_dpp v121, v121, v121 row_shr:8 row_mask:0xf bank_mask:0xf bound_ctrl:0
    s_nop 1
    v_add_u32_dpp v121, v121, v121 row_bcast:15 row_mask:0xa bank_mask:0xf
    s_nop 1
    v_add_u32_dpp v121, v121, v121 row_bcast:31 row_mask:0xc bank_mask:0xf
    s_nop 0
    v_readlane_b32 s38, v121, 63
    v_and_b32 v121, 0xffff, v121
    v_sub_u32 v121, v121, v111
    s_lshr_b32 s38, s38, 16
    v_add_u32 v121, s38, v121
    v_add_u32 v108, v108, v121
    v_add_u32 v109, v109, v121
    v_add_u32 v110, v110, v121
    v_add_u32 v111, v111, v121
    v_mul_u32_u24 v112, 20, v108
    v_mul_u32_u24 v113, 20, v109
    v_mul_u32_u24 v114, 20, v110
    v_mul_u32_u24 v115, 20, v111
    ds_write_b32 v112, v123 offset:12316
    ds_write_b32 v113, v123 offset:12316
    ds_write_b32 v114, v123 offset:12316
    ds_write_b32 v115, v123 offset:12316
    v_sub_u32 v108, v108, v104
    v_sub_u32 v109, v109, v105
    v_sub_u32 v110, v110, v106
    v_sub_u32 v111, v111, v107
    v_mul_u32_u24 v116, 20, v108
    v_mul_u32_u24 v117, 20, v109
    v_mul_u32_u24 v118, 20, v110
    v_mul_u32_u24 v119, 20, v111
    ds_write_b128 v1, v[116:119] offset:8192
    v_add_u32 v115, 127, v115
    v_and_b32 v115, -128, v115
    v_cmpx_eq_u32 vcc, 255, v0
    ds_write_b32 v123, v115 offset:12288
    s_mov_b64 exec, -1
    s_waitcnt lgkmcnt(0)
    s_barrier
    v_lshl_or_b32 v104, v104, 16, v108
    v_lshl_or_b32 v105, v105, 16, v109
    v_lshl_or_b32 v106, v106, 16, v110
    v_lshl_or_b32 v107, v107, 16, v111
    s_and_b32 s38, s33, 1
    s_lshl_b32 s38, s38, 3
    s_and_b32 s39, s33, 2
    s_lshl_b32 s39, s39, 1
    s_add_u32 s38, s38, s39
    s_add_u32 s38, s38, 130080
    v_lshl_add_u32 v120, v120, 3, s38
    ds_write_b32 v120, v104 offset:0
    ds_write_b32 v120, v105 offset:32
    ds_write_b32 v120, v106 offset:64
    ds_write_b32 v120, v107 offset:96
    s_setprio 0
Lp_skipB0:
    s_add_u32 s35, s34, 1280000
    buffer_load_dwordx4 v[54:57], v1, s[16:19], s35 offen nt
    s_cmp_lg_u32 s33, 8
    s_cbranch_scc1 Lp_nomax
    v_mov_b32 v122, 0
    ds_read_b32 v123, v122 offset:12296
    s_lshl_b32 s39, s2, 2
    s_add_u32 s39, s39, 7340032
    s_mov_b64 exec, 1
    s_waitcnt lgkmcnt(0)
    buffer_store_dword v123, v122, s[28:31], s39 offen sc1
    s_mov_b64 exec, -1
Lp_nomax:
    s_cmp_lt_u32 s33, 4
    s_cbranch_scc1 Lp_skipBB0
    s_barrier
Lp_skipBB0:
    v_mov_b32 v3, 5
    v_mov_b32 v120, 0
    ds_read_b32 v120, v120 offset:12288
    ds_add_rtn_u32 v4, v4, v3 offset:8192
    ds_add_rtn_u32 v5, v5, v3 offset:8192
    ds_add_rtn_u32 v6, v6, v3 offset:8192
    ds_add_rtn_u32 v7, v7, v3 offset:8192
    ds_add_rtn_u32 v8, v8, v3 offset:8192
    ds_add_rtn_u32 v9, v9, v3 offset:8192
    ds_add_rtn_u32 v10, v10, v3 offset:8192
    ds_add_rtn_u32 v11, v11, v3 offset:8192
    s_add_u32 s35, s34, 1280000
    buffer_load_dwordx4 v[74:77], v1, s[12:15], s35 offen nt
    s_waitcnt lgkmcnt(4)
    v_and_b32 v124, 3, v4
    v_lshrrev_b32 v125, 20, v24
    v_mad_i32_i24 v124, v124, -4, v4
    v_add_u32 v125, 49, v125
    v_and_b32 v4, -4, v4
    v_and_b32 v24, 0xfffff, v24
    ds_write_b8 v124, v125 offset:12336
    v_and_b32 v126, 3, v5
    v_lshrrev_b32 v127, 20, v25
    v_mad_i32_i24 v126, v126, -4, v5
    v_add_u32 v127, 49, v127
    v_and_b32 v5, -4, v5
    v_and_b32 v25, 0xfffff, v25
    ds_write_b8 v126, v127 offset:12336
    v_and_b32 v124, 3, v6
    v_lshrrev_b32 v125, 20, v26
    v_mad_i32_i24 v124, v124, -4, v6
    v_add_u32 v125, 49, v125
    v_and_b32 v6, -4, v6
    v_and_b32 v26, 0xfffff, v26
    ds_write_b8 v124, v125 offset:12336
    v_and_b32 v126, 3, v7
    v_lshrrev_b32 v127, 20, v27
    v_mad_i32_i24 v126, v126, -4, v7
    v_add_u32 v127, 49, v127
    v_and_b32 v7, -4, v7
    v_and_b32 v27, 0xfffff, v27
    ds_write_b8 v126, v127 offset:12336
    ds_add_rtn_u32 v12, v12, v3 offset:8192
    ds_add_rtn_u32 v13, v13, v3 offset:8192
    ds_add_rtn_u32 v14, v14, v3 offset:8192
    ds_add_rtn_u32 v15, v15, v3 offset:8192
    s_waitcnt lgkmcnt(8)
    v_and_b32 v124, 3, v8
    v_lshrrev_b32 v125, 20, v28
    v_mad_i32_i24 v124, v124, -4, v8
    v_add_u32 v125, 49, v125
    v_and_b32 v8, -4, v8
    v_and_b32 v28, 0xfffff, v28
    ds_write_b8 v124, v125 offset:12336
    v_and_b32 v126, 3, v9
    v_lshrrev_b32 v127, 20, v29
    v_mad_i32_i24 v126, v126, -4, v9
    v_add_u32 v127, 49, v127
    v_and_b32 v9, -4, v9
    v_and_b32 v29, 0xfffff, v29
    ds_write_b8 v126, v127 offset:12336
    v_and_b32 v124, 3, v10
    v_lshrrev_b32 v125, 20, v30
    v_mad_i32_i24 v124, v124, -4, v10
    v_add_u32 v125, 49, v125
    v_and_b32 v10, -4, v10
    v_and_b32 v30, 0xfffff, v30
    ds_write_b8 v124, v125 offset:12336
    v_and_b32 v126, 3, v11
    v_lshrrev_b32 v127, 20, v31
    v_mad_i32_i24 v126, v126, -4, v11
    v_add_u32 v127, 49, v127
    v_and_b32 v11, -4, v11
    v_and_b32 v31, 0xfffff, v31
    ds_write_b8 v126, v127 offset:12336
    ds_add_rtn_u32 v16, v16, v3 offset:8192
    ds_add_rtn_u32 v17, v17, v3 offset:8192
    ds_add_rtn_u32 v18, v18, v3 offset:8192
    ds_add_rtn_u32 v19, v19, v3 offset:8192
    s_add_u32 s35, s34, 1536000
    buffer_load_dwordx4 v[58:61], v1, s[16:19], s35 offen nt
    s_waitcnt lgkmcnt(8)
    v_and_b32 v124, 3, v12
    v_lshrrev_b32 v125, 20, v32
    v_mad_i32_i24 v124, v124, -4, v12
    v_add_u32 v125, 49, v125
    v_and_b32 v12, -4, v12
    v_and_b32 v32, 0xfffff, v32
    ds_write_b8 v124, v125 offset:12336
    v_and_b32 v126, 3, v13
    v_lshrrev_b32 v127, 20, v33
    v_mad_i32_i24 v126, v126, -4, v13
    v_add_u32 v127, 49, v127
    v_and_b32 v13, -4, v13
    v_and_b32 v33, 0xfffff, v33
    ds_write_b8 v126, v127 offset:12336
    v_and_b32 v124, 3, v14
    v_lshrrev_b32 v125, 20, v34
    v_mad_i32_i24 v124, v124, -4, v14
    v_add_u32 v125, 49, v125
    v_and_b32 v14, -4, v14
    v_and_b32 v34, 0xfffff, v34
    ds_write_b8 v124, v125 offset:12336
    v_and_b32 v126, 3, v15
    v_lshrrev_b32 v127, 20, v35
    v_mad_i32_i24 v126, v126, -4, v15
    v_add_u32 v127, 49, v127
    v_and_b32 v15, -4, v15
    v_and_b32 v35, 0xfffff, v35
    ds_write_b8 v126, v127 offset:12336
    ds_add_rtn_u32 v20, v20, v3 offset:8192
    ds_add_rtn_u32 v21, v21, v3 offset:8192
    ds_add_rtn_u32 v22, v22, v3 offset:8192
    ds_add_rtn_u32 v23, v23, v3 offset:8192
    s_add_u32 s35, s34, 1536000
    buffer_load_dwordx4 v[78:81], v1, s[12:15], s35 offen nt
    s_waitcnt lgkmcnt(8)
    v_and_b32 v124, 3, v16
    v_lshrrev_b32 v125, 20, v36
    v_mad_i32_i24 v124, v124, -4, v16
    v_add_u32 v125, 49, v125
    v_and_b32 v16, -4, v16
    v_and_b32 v36, 0xfffff, v36
    ds_write_b8 v124, v125 offset:12336
    v_and_b32 v126, 3, v17
    v_lshrrev_b32 v127, 20, v37
    v_mad_i32_i24 v126, v126, -4, v17
    v_add_u32 v127, 49, v127
    v_and_b32 v17, -4, v17
    v_and_b32 v37, 0xfffff, v37
    ds_write_b8 v126, v127 offset:12336
    v_and_b32 v124, 3, v18
    v_lshrrev_b32 v125, 20, v38
    v_mad_i32_i24 v124, v124, -4, v18
    v_add_u32 v125, 49, v125
    v_and_b32 v18, -4, v18
    v_and_b32 v38, 0xfffff, v38
    ds_write_b8 v124, v125 offset:12336
    v_and_b32 v126, 3, v19
    v_lshrrev_b32 v127, 20, v39
    v_mad_i32_i24 v126, v126, -4, v19
    v_add_u32 v127, 49, v127
    v_and_b32 v19, -4, v19
    v_and_b32 v39, 0xfffff, v39
    ds_write_b8 v126, v127 offset:12336
    s_waitcnt lgkmcnt(4)
    v_and_b32 v124, 3, v20
    v_lshrrev_b32 v125, 20, v40
    v_mad_i32_i24 v124, v124, -4, v20
    v_add_u32 v125, 49, v125
    v_and_b32 v20, -4, v20
    v_and_b32 v40, 0xfffff, v40
    ds_write_b8 v124, v125 offset:12336
    v_and_b32 v126, 3, v21
    v_lshrrev_b32 v127, 20, v41
    v_mad_i32_i24 v126, v126, -4, v21
    v_add_u32 v127, 49, v127
    v_and_b32 v21, -4, v21
    v_and_b32 v41, 0xfffff, v41
    ds_write_b8 v126, v127 offset:12336
    v_and_b32 v124, 3, v22
    v_lshrrev_b32 v125, 20, v42
    v_mad_i32_i24 v124, v124, -4, v22
    v_add_u32 v125, 49, v125
    v_and_b32 v22, -4, v22
    v_and_b32 v42, 0xfffff, v42
    ds_write_b8 v124, v125 offset:12336
    v_and_b32 v126, 3, v23
    v_lshrrev_b32 v127, 20, v43
    v_mad_i32_i24 v126, v126, -4, v23
    v_add_u32 v127, 49, v127
    v_and_b32 v23, -4, v23
    v_and_b32 v43, 0xfffff, v43
    ds_write_b8 v126, v127 offset:12336
    v_readfirstlane_b32 s26, v120
    s_cmp_eq_u32 s33, 15
    s_cselect_b32 s26, 0, s26
    v_mov_b32 v121, 0xfff00000
    v_mov_b32 v122, 0x4effe000
    s_add_u32 s35, s34, 1792000
    buffer_load_dwordx4 v[62:65], v1, s[16:19], s35 offen nt
    s_waitcnt vmcnt(9)
    v_lshlrev_b32 v124, 16, v44
    v_and_b32 v125, 0xffff0000, v44
    v_mul_f32 v124, 0.15915494, v124
    v_mul_f32 v125, 0.15915494, v125
    v_fract_f32 v124, v124
    v_fract_f32 v125, v125
    v_cos_f32 v124, v124
    v_cos_f32 v125, v125
    v_fmaak_f32 v124, v124, v122, 0x49000000
    v_fmaak_f32 v125, v125, v122, 0x49000000
    v_cvt_i32_f32 v124, v124
    v_cvt_i32_f32 v125, v125
    v_sub_u32 v124, v124, v24
    v_bitop3_b32 v124, v121, v124, v24 bitop3:0xca
    ds_write_b32 v4, v124 offset:12320
    v_sub_u32 v125, v125, v25
    v_bitop3_b32 v125, v121, v125, v25 bitop3:0xca
    ds_write_b32 v5, v125 offset:12320
    v_lshlrev_b32 v126, 16, v45
    v_and_b32 v127, 0xffff0000, v45
    v_mul_f32 v126, 0.15915494, v126
    v_mul_f32 v127, 0.15915494, v127
    v_fract_f32 v126, v126
    v_fract_f32 v127, v127
    v_cos_f32 v126, v126
    v_cos_f32 v127, v127
    v_fmaak_f32 v126, v126, v122, 0x49000000
    v_fmaak_f32 v127, v127, v122, 0x49000000
    v_cvt_i32_f32 v126, v126
    v_cvt_i32_f32 v127, v127
    v_sub_u32 v126, v126, v26
    v_bitop3_b32 v126, v121, v126, v26 bitop3:0xca
    ds_write_b32 v6, v126 offset:12320
    v_sub_u32 v127, v127, v27
    v_bitop3_b32 v127, v121, v127, v27 bitop3:0xca
    ds_write_b32 v7, v127 offset:12320
    s_waitcnt vmcnt(8)
    v_lshlrev_b32 v124, 16, v46
    v_and_b32 v125, 0xffff0000, v46
    v_mul_f32 v124, 0.15915494, v124
    v_mul_f32 v125, 0.15915494, v125
    v_fract_f32 v124, v124
    v_fract_f32 v125, v125
    v_cos_f32 v124, v124
    v_cos_f32 v125, v125
    v_fmaak_f32 v124, v124, v122, 0x49000000
    v_fmaak_f32 v125, v125, v122, 0x49000000
    v_cvt_i32_f32 v124, v124
    v_cvt_i32_f32 v125, v125
    v_sub_u32 v124, v124, v28
    v_bitop3_b32 v124, v121, v124, v28 bitop3:0xca
    ds_write_b32 v8, v124 offset:12320
    v_sub_u32 v125, v125, v29
    v_bitop3_b32 v125, v121, v125, v29 bitop3:0xca
    ds_write_b32 v9, v125 offset:12320
    v_lshlrev_b32 v126, 16, v47
    v_and_b32 v127, 0xffff0000, v47
    v_mul_f32 v126, 0.15915494, v126
    v_mul_f32 v127, 0.15915494, v127
    v_fract_f32 v126, v126
    v_fract_f32 v127, v127
    v_cos_f32 v126, v126
    v_cos_f32 v127, v127
    v_fmaak_f32 v126, v126, v122, 0x49000000
    v_fmaak_f32 v127, v127, v122, 0x49000000
    v_cvt_i32_f32 v126, v126
    v_cvt_i32_f32 v127, v127
    v_sub_u32 v126, v126, v30
    v_bitop3_b32 v126, v121, v126, v30 bitop3:0xca
    ds_write_b32 v10, v126 offset:12320
    v_sub_u32 v127, v127, v31
    v_bitop3_b32 v127, v121, v127, v31 bitop3:0xca
    ds_write_b32 v11, v127 offset:12320
    s_add_u32 s35, s34, 1792000
    buffer_load_dwordx4 v[82:85], v1, s[12:15], s35 offen nt
    s_waitcnt vmcnt(8)
    v_lshlrev_b32 v124, 16, v48
    v_and_b32 v125, 0xffff0000, v48
    v_mul_f32 v124, 0.15915494, v124
    v_mul_f32 v125, 0.15915494, v125
    v_fract_f32 v124, v124
    v_fract_f32 v125, v125
    v_cos_f32 v124, v124
    v_cos_f32 v125, v125
    v_fmaak_f32 v124, v124, v122, 0x49000000
    v_fmaak_f32 v125, v125, v122, 0x49000000
    v_cvt_i32_f32 v124, v124
    v_cvt_i32_f32 v125, v125
    v_sub_u32 v124, v124, v32
    v_bitop3_b32 v124, v121, v124, v32 bitop3:0xca
    ds_write_b32 v12, v124 offset:12320
    v_sub_u32 v125, v125, v33
    v_bitop3_b32 v125, v121, v125, v33 bitop3:0xca
    ds_write_b32 v13, v125 offset:12320
    v_lshlrev_b32 v126, 16, v49
    v_and_b32 v127, 0xffff0000, v49
    v_mul_f32 v126, 0.15915494, v126
    v_mul_f32 v127, 0.15915494, v127
    v_fract_f32 v126, v126
    v_fract_f32 v127, v127
    v_cos_f32 v126, v126
    v_cos_f32 v127, v127
    v_fmaak_f32 v126, v126, v122, 0x49000000
    v_fmaak_f32 v127, v127, v122, 0x49000000
    v_cvt_i32_f32 v126, v126
    v_cvt_i32_f32 v127, v127
    v_sub_u32 v126, v126, v34
    v_bitop3_b32 v126, v121, v126, v34 bitop3:0xca
    ds_write_b32 v14, v126 offset:12320
    v_sub_u32 v127, v127, v35
    v_bitop3_b32 v127, v121, v127, v35 bitop3:0xca
    ds_write_b32 v15, v127 offset:12320
    s_waitcnt vmcnt(7)
    v_lshlrev_b32 v124, 16, v50
    v_and_b32 v125, 0xffff0000, v50
    v_mul_f32 v124, 0.15915494, v124
    v_mul_f32 v125, 0.15915494, v125
    v_fract_f32 v124, v124
    v_fract_f32 v125, v125
    v_cos_f32 v124, v124
    v_cos_f32 v125, v125
    v_fmaak_f32 v124, v124, v122, 0x49000000
    v_fmaak_f32 v125, v125, v122, 0x49000000
    v_cvt_i32_f32 v124, v124
    v_cvt_i32_f32 v125, v125
    v_sub_u32 v124, v124, v36
    v_bitop3_b32 v124, v121, v124, v36 bitop3:0xca
    ds_write_b32 v16, v124 offset:12320
    v_sub_u32 v125, v125, v37
    v_bitop3_b32 v125, v121, v125, v37 bitop3:0xca
    ds_write_b32 v17, v125 offset:12320
    v_lshlrev_b32 v126, 16, v51
    v_and_b32 v127, 0xffff0000, v51
    v_mul_f32 v126, 0.15915494, v126
    v_mul_f32 v127, 0.15915494, v127
    v_fract_f32 v126, v126
    v_fract_f32 v127, v127
    v_cos_f32 v126, v126
    v_cos_f32 v127, v127
    v_fmaak_f32 v126, v126, v122, 0x49000000
    v_fmaak_f32 v127, v127, v122, 0x49000000
    v_cvt_i32_f32 v126, v126
    v_cvt_i32_f32 v127, v127
    v_sub_u32 v126, v126, v38
    v_bitop3_b32 v126, v121, v126, v38 bitop3:0xca
    ds_write_b32 v18, v126 offset:12320
    v_sub_u32 v127, v127, v39
    v_bitop3_b32 v127, v121, v127, v39 bitop3:0xca
    ds_write_b32 v19, v127 offset:12320
    s_add_u32 s35, s34, 2048000
    buffer_load_dwordx4 v[66:69], v1, s[16:19], s35 offen nt
    s_waitcnt vmcnt(7)
    v_lshlrev_b32 v124, 16, v52
    v_and_b32 v125, 0xffff0000, v52
    v_mul_f32 v124, 0.15915494, v124
    v_mul_f32 v125, 0.15915494, v125
    v_fract_f32 v124, v124
    v_fract_f32 v125, v125
    v_cos_f32 v124, v124
    v_cos_f32 v125, v125
    v_fmaak_f32 v124, v124, v122, 0x49000000
    v_fmaak_f32 v125, v125, v122, 0x49000000
    v_cvt_i32_f32 v124, v124
    v_cvt_i32_f32 v125, v125
    v_sub_u32 v124, v124, v40
    v_bitop3_b32 v124, v121, v124, v40 bitop3:0xca
    ds_write_b32 v20, v124 offset:12320
    v_sub_u32 v125, v125, v41
    v_bitop3_b32 v125, v121, v125, v41 bitop3:0xca
    ds_write_b32 v21, v125 offset:12320
    v_lshlrev_b32 v126, 16, v53
    v_and_b32 v127, 0xffff0000, v53
    v_mul_f32 v126, 0.15915494, v126
    v_mul_f32 v127, 0.15915494, v127
    v_fract_f32 v126, v126
    v_fract_f32 v127, v127
    v_cos_f32 v126, v126
    v_cos_f32 v127, v127
    v_fmaak_f32 v126, v126, v122, 0x49000000
    v_fmaak_f32 v127, v127, v122, 0x49000000
    v_cvt_i32_f32 v126, v126
    v_cvt_i32_f32 v127, v127
    v_sub_u32 v126, v126, v42
    v_bitop3_b32 v126, v121, v126, v42 bitop3:0xca
    ds_write_b32 v22, v126 offset:12320
    v_sub_u32 v127, v127, v43
    v_bitop3_b32 v127, v121, v127, v43 bitop3:0xca
    ds_write_b32 v23, v127 offset:12320
    v_add_u32 v120, 0x10000, v1
    s_waitcnt lgkmcnt(0)
    s_barrier
    ds_read_b128 v[4:7], v1 offset:12320
    ds_read_b128 v[8:11], v1 offset:27680
    ds_read_b128 v[12:15], v1 offset:43040
    ds_read_b128 v[16:19], v1 offset:58400
    ds_read_b128 v[20:23], v120 offset:8224
    ds_read_b128 v[24:27], v120 offset:23584
    ds_read_b128 v[28:31], v120 offset:38944
    ds_read_b128 v[32:35], v120 offset:54304
    s_setprio 3
    s_add_u32 s35, s34, 2048000
    buffer_load_dwordx4 v[86:89], v1, s[12:15], s35 offen nt
    s_waitcnt vmcnt(6)
    v_mov_b32 v3, 1
    v_mov_b32 v122, 131760
    v_mul_hi_u32_u24 v125, 9586981, v74
    v_mul_hi_u32_u24 v104, 3435974, v54
    v_mad_u32_u24 v120, v125, s42, v122
    v_mul_u32_u24 v124, 1250, v104
    v_mad_i32_i24 v74, v125, s44, v74
    v_and_b32 v124, -16, v124
    v_bfe_u32 v120, v120, 19, 2
    v_sub_u32 v124, v54, v124
    v_lshl_or_b32 v104, v120, 8, v104
    v_lshl_or_b32 v74, v124, 9, v74
    v_mad_i32_i24 v125, v120, s43, v125
    v_lshlrev_b32 v54, 2, v104
    v_lshl_or_b32 v74, v125, 20, v74
    ds_add_u32 v54, v3 offset:4096
    v_mul_hi_u32_u24 v127, 9586981, v75
    v_mul_hi_u32_u24 v105, 3435974, v55
    v_mad_u32_u24 v121, v127, s42, v122
    v_mul_u32_u24 v126, 1250, v105
    v_mad_i32_i24 v75, v127, s44, v75
    v_and_b32 v126, -16, v126
    v_bfe_u32 v121, v121, 19, 2
    v_sub_u32 v126, v55, v126
    v_lshl_or_b32 v105, v121, 8, v105
    v_lshl_or_b32 v75, v126, 9, v75
    v_mad_i32_i24 v127, v121, s43, v127
    v_lshlrev_b32 v55, 2, v105
    v_lshl_or_b32 v75, v127, 20, v75
    ds_add_u32 v55, v3 offset:4096
    v_mul_hi_u32_u24 v125, 9586981, v76
    v_mul_hi_u32_u24 v104, 3435974, v56
    v_mad_u32_u24 v120, v125, s42, v122
    v_mul_u32_u24 v124, 1250, v104
    v_mad_i32_i24 v76, v125, s44, v76
    v_and_b32 v124, -16, v124
    v_bfe_u32 v120, v120, 19, 2
    v_sub_u32 v124, v56, v124
    v_lshl_or_b32 v104, v120, 8, v104
    v_lshl_or_b32 v76, v124, 9, v76
    v_mad_i32_i24 v125, v120, s43, v125
    v_lshlrev_b32 v56, 2, v104
    v_lshl_or_b32 v76, v125, 20, v76
    ds_add_u32 v56, v3 offset:4096
    v_mul_hi_u32_u24 v127, 9586981, v77
    v_mul_hi_u32_u24 v105, 3435974, v57
    v_mad_u32_u24 v121, v127, s42, v122
    v_mul_u32_u24 v126, 1250, v105
    v_mad_i32_i24 v77, v127, s44, v77
    v_and_b32 v126, -16, v126
    v_bfe_u32 v121, v121, 19, 2
    v_sub_u32 v126, v57, v126
    v_lshl_or_b32 v105, v121, 8, v105
    v_lshl_or_b32 v77, v126, 9, v77
    v_mad_i32_i24 v127, v121, s43, v127
    v_lshlrev_b32 v57, 2, v105
    v_lshl_or_b32 v77, v127, 20, v77
    ds_add_u32 v57, v3 offset:4096
    s_setprio 2
    s_add_u32 s35, s34, 2304000
    buffer_load_dwordx4 v[70:73], v1, s[16:19], s35 offen nt
    s_waitcnt vmcnt(5)
    v_mov_b32 v3, 1
    v_mov_b32 v122, 131760
    v_mul_hi_u32_u24 v125, 9586981, v78
    v_mul_hi_u32_u24 v104, 3435974, v58
    v_mad_u32_u24 v120, v125, s42, v122
    v_mul_u32_u24 v124, 1250, v104
    v_mad_i32_i24 v78, v125, s44, v78
    v_and_b32 v124, -16, v124
    v_bfe_u32 v120, v120, 19, 2
    v_sub_u32 v124, v58, v124
    v_lshl_or_b32 v104, v120, 8, v104
    v_lshl_or_b32 v78, v124, 9, v78
    v_mad_i32_i24 v125, v120, s43, v125
    v_lshlrev_b32 v58, 2, v104
    v_lshl_or_b32 v78, v125, 20, v78
    ds_add_u32 v58, v3 offset:4096
    v_mul_hi_u32_u24 v127, 9586981, v79
    v_mul_hi_u32_u24 v105, 3435974, v59
    v_mad_u32_u24 v121, v127, s42, v122
    v_mul_u32_u24 v126, 1250, v105
    v_mad_i32_i24 v79, v127, s44, v79
    v_and_b32 v126, -16, v126
    v_bfe_u32 v121, v121, 19, 2
    v_sub_u32 v126, v59, v126
    v_lshl_or_b32 v105, v121, 8, v105
    v_lshl_or_b32 v79, v126, 9, v79
    v_mad_i32_i24 v127, v121, s43, v127
    v_lshlrev_b32 v59, 2, v105
    v_lshl_or_b32 v79, v127, 20, v79
    ds_add_u32 v59, v3 offset:4096
    v_mul_hi_u32_u24 v125, 9586981, v80
    v_mul_hi_u32_u24 v104, 3435974, v60
    v_mad_u32_u24 v120, v125, s42, v122
    v_mul_u32_u24 v124, 1250, v104
    v_mad_i32_i24 v80, v125, s44, v80
    v_and_b32 v124, -16, v124
    v_bfe_u32 v120, v120, 19, 2
    v_sub_u32 v124, v60, v124
    v_lshl_or_b32 v104, v120, 8, v104
    v_lshl_or_b32 v80, v124, 9, v80
    v_mad_i32_i24 v125, v120, s43, v125
    v_lshlrev_b32 v60, 2, v104
    v_lshl_or_b32 v80, v125, 20, v80
    ds_add_u32 v60, v3 offset:4096
    v_mul_hi_u32_u24 v127, 9586981, v81
    v_mul_hi_u32_u24 v105, 3435974, v61
    v_mad_u32_u24 v121, v127, s42, v122
    v_mul_u32_u24 v126, 1250, v105
    v_mad_i32_i24 v81, v127, s44, v81
    v_and_b32 v126, -16, v126
    v_bfe_u32 v121, v121, 19, 2
    v_sub_u32 v126, v61, v126
    v_lshl_or_b32 v105, v121, 8, v105
    v_lshl_or_b32 v81, v126, 9, v81
    v_mad_i32_i24 v127, v121, s43, v127
    v_lshlrev_b32 v61, 2, v105
    v_lshl_or_b32 v81, v127, 20, v81
    ds_add_u32 v61, v3 offset:4096
    s_setprio 1
    s_add_u32 s35, s34, 2304000
    buffer_load_dwordx4 v[90:93], v1, s[12:15], s35 offen nt
    s_waitcnt vmcnt(4)
    v_mov_b32 v3, 1
    v_mov_b32 v122, 131760
    v_mul_hi_u32_u24 v125, 9586981, v82
    v_mul_hi_u32_u24 v104, 3435974, v62
    v_mad_u32_u24 v120, v125, s42, v122
    v_mul_u32_u24 v124, 1250, v104
    v_mad_i32_i24 v82, v125, s44, v82
    v_and_b32 v124, -16, v124
    v_bfe_u32 v120, v120, 19, 2
    v_sub_u32 v124, v62, v124
    v_lshl_or_b32 v104, v120, 8, v104
    v_lshl_or_b32 v82, v124, 9, v82
    v_mad_i32_i24 v125, v120, s43, v125
    v_lshlrev_b32 v62, 2, v104
    v_lshl_or_b32 v82, v125, 20, v82
    ds_add_u32 v62, v3 offset:4096
    v_mul_hi_u32_u24 v127, 9586981, v83
    v_mul_hi_u32_u24 v105, 3435974, v63
    v_mad_u32_u24 v121, v127, s42, v122
    v_mul_u32_u24 v126, 1250, v105
    v_mad_i32_i24 v83, v127, s44, v83
    v_and_b32 v126, -16, v126
    v_bfe_u32 v121, v121, 19, 2
    v_sub_u32 v126, v63, v126
    v_lshl_or_b32 v105, v121, 8, v105
    v_lshl_or_b32 v83, v126, 9, v83
    v_mad_i32_i24 v127, v121, s43, v127
    v_lshlrev_b32 v63, 2, v105
    v_lshl_or_b32 v83, v127, 20, v83
    ds_add_u32 v63, v3 offset:4096
    v_mul_hi_u32_u24 v125, 9586981, v84
    v_mul_hi_u32_u24 v104, 3435974, v64
    v_mad_u32_u24 v120, v125, s42, v122
    v_mul_u32_u24 v124, 1250, v104
    v_mad_i32_i24 v84, v125, s44, v84
    v_and_b32 v124, -16, v124
    v_bfe_u32 v120, v120, 19, 2
    v_sub_u32 v124, v64, v124
    v_lshl_or_b32 v104, v120, 8, v104
    v_lshl_or_b32 v84, v124, 9, v84
    v_mad_i32_i24 v125, v120, s43, v125
    v_lshlrev_b32 v64, 2, v104
    v_lshl_or_b32 v84, v125, 20, v84
    ds_add_u32 v64, v3 offset:4096
    v_mul_hi_u32_u24 v127, 9586981, v85
    v_mul_hi_u32_u24 v105, 3435974, v65
    v_mad_u32_u24 v121, v127, s42, v122
    v_mul_u32_u24 v126, 1250, v105
    v_mad_i32_i24 v85, v127, s44, v85
    v_and_b32 v126, -16, v126
    v_bfe_u32 v121, v121, 19, 2
    v_sub_u32 v126, v65, v126
    v_lshl_or_b32 v105, v121, 8, v105
    v_lshl_or_b32 v85, v126, 9, v85
    v_mad_i32_i24 v127, v121, s43, v127
    v_lshlrev_b32 v65, 2, v105
    v_lshl_or_b32 v85, v127, 20, v85
    ds_add_u32 v65, v3 offset:4096
    s_setprio 0
    s_add_u32 s35, s36, 640000
    buffer_load_dwordx2 v[94:95], v2, s[20:23], s35 offen nt
    s_add_u32 s35, s36, 768000
    buffer_load_dwordx2 v[96:97], v2, s[20:23], s35 offen nt
    s_waitcnt vmcnt(4)
    v_mov_b32 v3, 1
    v_mov_b32 v122, 131760
    v_mul_hi_u32_u24 v125, 9586981, v86
    v_mul_hi_u32_u24 v104, 3435974, v66
    v_mad_u32_u24 v120, v125, s42, v122
    v_mul_u32_u24 v124, 1250, v104
    v_mad_i32_i24 v86, v125, s44, v86
    v_and_b32 v124, -16, v124
    v_bfe_u32 v120, v120, 19, 2
    v_sub_u32 v124, v66, v124
    v_lshl_or_b32 v104, v120, 8, v104
    v_lshl_or_b32 v86, v124, 9, v86
    v_mad_i32_i24 v125, v120, s43, v125
    v_lshlrev_b32 v66, 2, v104
    v_lshl_or_b32 v86, v125, 20, v86
    ds_add_u32 v66, v3 offset:4096
    v_mul_hi_u32_u24 v127, 9586981, v87
    v_mul_hi_u32_u24 v105, 3435974, v67
    v_mad_u32_u24 v121, v127, s42, v122
    v_mul_u32_u24 v126, 1250, v105
    v_mad_i32_i24 v87, v127, s44, v87
    v_and_b32 v126, -16, v126
    v_bfe_u32 v121, v121, 19, 2
    v_sub_u32 v126, v67, v126
    v_lshl_or_b32 v105, v121, 8, v105
    v_lshl_or_b32 v87, v126, 9, v87
    v_mad_i32_i24 v127, v121, s43, v127
    v_lshlrev_b32 v67, 2, v105
    v_lshl_or_b32 v87, v127, 20, v87
    ds_add_u32 v67, v3 offset:4096
    v_mul_hi_u32_u24 v125, 9586981, v88
    v_mul_hi_u32_u24 v104, 3435974, v68
    v_mad_u32_u24 v120, v125, s42, v122
    v_mul_u32_u24 v124, 1250, v104
    v_mad_i32_i24 v88, v125, s44, v88
    v_and_b32 v124, -16, v124
    v_bfe_u32 v120, v120, 19, 2
    v_sub_u32 v124, v68, v124
    v_lshl_or_b32 v104, v120, 8, v104
    v_lshl_or_b32 v88, v124, 9, v88
    v_mad_i32_i24 v125, v120, s43, v125
    v_lshlrev_b32 v68, 2, v104
    v_lshl_or_b32 v88, v125, 20, v88
    ds_add_u32 v68, v3 offset:4096
    v_mul_hi_u32_u24 v127, 9586981, v89
    v_mul_hi_u32_u24 v105, 3435974, v69
    v_mad_u32_u24 v121, v127, s42, v122
    v_mul_u32_u24 v126, 1250, v105
    v_mad_i32_i24 v89, v127, s44, v89
    v_and_b32 v126, -16, v126
    v_bfe_u32 v121, v121, 19, 2
    v_sub_u32 v126, v69, v126
    v_lshl_or_b32 v105, v121, 8, v105
    v_lshl_or_b32 v89, v126, 9, v89
    v_mad_i32_i24 v127, v121, s43, v127
    v_lshlrev_b32 v69, 2, v105
    v_lshl_or_b32 v89, v127, 20, v89
    ds_add_u32 v69, v3 offset:4096
    s_add_u32 s35, s36, 896000
    buffer_load_dwordx2 v[98:99], v2, s[20:23], s35 offen nt
    s_add_u32 s35, s36, 1024000
    buffer_load_dwordx2 v[100:101], v2, s[20:23], s35 offen nt
    s_waitcnt vmcnt(4)
    v_mov_b32 v3, 1
    v_mov_b32 v122, 131760
    v_mul_hi_u32_u24 v125, 9586981, v90
    v_mul_hi_u32_u24 v104, 3435974, v70
    v_mad_u32_u24 v120, v125, s42, v122
    v_mul_u32_u24 v124, 1250, v104
    v_mad_i32_i24 v90, v125, s44, v90
    v_and_b32 v124, -16, v124
    v_bfe_u32 v120, v120, 19, 2
    v_sub_u32 v124, v70, v124
    v_lshl_or_b32 v104, v120, 8, v104
    v_lshl_or_b32 v90, v124, 9, v90
    v_mad_i32_i24 v125, v120, s43, v125
    v_lshlrev_b32 v70, 2, v104
    v_lshl_or_b32 v90, v125, 20, v90
    ds_add_u32 v70, v3 offset:4096
    v_mul_hi_u32_u24 v127, 9586981, v91
    v_mul_hi_u32_u24 v105, 3435974, v71
    v_mad_u32_u24 v121, v127, s42, v122
    v_mul_u32_u24 v126, 1250, v105
    v_mad_i32_i24 v91, v127, s44, v91
    v_and_b32 v126, -16, v126
    v_bfe_u32 v121, v121, 19, 2
    v_sub_u32 v126, v71, v126
    v_lshl_or_b32 v105, v121, 8, v105
    v_lshl_or_b32 v91, v126, 9, v91
    v_mad_i32_i24 v127, v121, s43, v127
    v_lshlrev_b32 v71, 2, v105
    v_lshl_or_b32 v91, v127, 20, v91
    ds_add_u32 v71, v3 offset:4096
    v_mul_hi_u32_u24 v125, 9586981, v92
    v_mul_hi_u32_u24 v104, 3435974, v72
    v_mad_u32_u24 v120, v125, s42, v122
    v_mul_u32_u24 v124, 1250, v104
    v_mad_i32_i24 v92, v125, s44, v92
    v_and_b32 v124, -16, v124
    v_bfe_u32 v120, v120, 19, 2
    v_sub_u32 v124, v72, v124
    v_lshl_or_b32 v104, v120, 8, v104
    v_lshl_or_b32 v92, v124, 9, v92
    v_mad_i32_i24 v125, v120, s43, v125
    v_lshlrev_b32 v72, 2, v104
    v_lshl_or_b32 v92, v125, 20, v92
    ds_add_u32 v72, v3 offset:4096
    v_mul_hi_u32_u24 v127, 9586981, v93
    v_mul_hi_u32_u24 v105, 3435974, v73
    v_mad_u32_u24 v121, v127, s42, v122
    v_mul_u32_u24 v126, 1250, v105
    v_mad_i32_i24 v93, v127, s44, v93
    v_and_b32 v126, -16, v126
    v_bfe_u32 v121, v121, 19, 2
    v_sub_u32 v126, v73, v126
    v_lshl_or_b32 v105, v121, 8, v105
    v_lshl_or_b32 v93, v126, 9, v93
    v_mad_i32_i24 v127, v121, s43, v127
    v_lshlrev_b32 v73, 2, v105
    v_lshl_or_b32 v93, v127, 20, v93
    ds_add_u32 v73, v3 offset:4096
    s_add_u32 s35, s36, 1152000
    buffer_load_dwordx2 v[102:103], v2, s[20:23], s35 offen nt
    s_waitcnt lgkmcnt(0)
    s_barrier
    s_cmp_ge_u32 s33, 4
    s_cbranch_scc1 Lp_skipB1
    s_setprio 3
    v_and_b32 v120, 0x3f0, v1
    ds_read_b128 v[104:107], v1 offset:4096
    ds_read_b128 v[108:111], v120 offset:4096
    ds_read_b128 v[112:115], v120 offset:5120
    ds_read_b128 v[116:119], v120 offset:6144
    v_mov_b32 v123, 0
    s_cmp_gt_u32 s33, 0
    s_cselect_b32 s37, -1, 0
    s_cmp_gt_u32 s33, 1
    s_cselect_b32 s38, -1, 0
    s_cmp_gt_u32 s33, 2
    s_cselect_b32 s39, -1, 0
    s_waitcnt lgkmcnt(0)
    v_add_u32 v104, 3, v104
    v_add_u32 v105, 3, v105
    v_add_u32 v106, 3, v106
    v_add_u32 v107, 3, v107
    v_add_u32 v108, 3, v108
    v_add_u32 v109, 3, v109
    v_add_u32 v110, 3, v110
    v_add_u32 v111, 3, v111
    v_add_u32 v112, 3, v112
    v_add_u32 v113, 3, v113
    v_add_u32 v114, 3, v114
    v_add_u32 v115, 3, v115
    v_add_u32 v116, 3, v116
    v_add_u32 v117, 3, v117
    v_add_u32 v118, 3, v118
    v_add_u32 v119, 3, v119
    v_lshrrev_b32 v104, 2, v104
    v_lshrrev_b32 v105, 2, v105
    v_lshrrev_b32 v106, 2, v106
    v_lshrrev_b32 v107, 2, v107
    v_lshrrev_b32 v108, 2, v108
    v_lshrrev_b32 v109, 2, v109
    v_lshrrev_b32 v110, 2, v110
    v_lshrrev_b32 v111, 2, v111
    v_lshrrev_b32 v112, 2, v112
    v_lshrrev_b32 v113, 2, v113
    v_lshrrev_b32 v114, 2, v114
    v_lshrrev_b32 v115, 2, v115
    v_lshrrev_b32 v116, 2, v116
    v_lshrrev_b32 v117, 2, v117
    v_lshrrev_b32 v118, 2, v118
    v_lshrrev_b32 v119, 2, v119
    v_add3_u32 v108, v108, v109, v110
    v_add_u32 v108, v108, v111
    v_and_b32 v108, s37, v108
    v_add3_u32 v112, v112, v113, v114
    v_add_u32 v112, v112, v115
    v_and_b32 v112, s38, v112
    v_add3_u32 v116, v116, v117, v118
    v_add_u32 v116, v116, v119
    v_and_b32 v116, s39, v116
    v_add3_u32 v121, v108, v112, v116
    v_mov_b32 v108, v104
    v_add_u32 v109, v108, v105
    v_add_u32 v110, v109, v106
    v_add_u32 v111, v110, v107
    v_lshl_or_b32 v121, v121, 16, v111
    s_nop 1
    v_add_u32_dpp v121, v121, v121 row_shr:1 row_mask:0xf bank_mask:0xf bound_ctrl:0
    s_nop 1
    v_add_u32_dpp v121, v121, v121 row_shr:2 row_mask:0xf bank_mask:0xf bound_ctrl:0
    s_nop 1
    v_add_u32_dpp v121, v121, v121 row_shr:4 row_mask:0xf bank_mask:0xf bound_ctrl:0
    s_nop 1
    v_add_u32_dpp v121, v121, v121 row_shr:8 row_mask:0xf bank_mask:0xf bound_ctrl:0
    s_nop 1
    v_add_u32_dpp v121, v121, v121 row_bcast:15 row_mask:0xa bank_mask:0xf
    s_nop 1
    v_add_u32_dpp v121, v121, v121 row_bcast:31 row_mask:0xc bank_mask:0xf
    s_nop 0
    v_readlane_b32 s38, v121, 63
    v_and_b32 v121, 0xffff, v121
    v_sub_u32 v121, v121, v111
    s_lshr_b32 s38, s38, 16
    v_add_u32 v121, s38, v121
    v_add_u32 v108, v108, v121
    v_add_u32 v109, v109, v121
    v_add_u32 v110, v110, v121
    v_add_u32 v111, v111, v121
    v_mul_u32_u24 v112, 20, v108
    v_mul_u32_u24 v113, 20, v109
    v_mul_u32_u24 v114, 20, v110
    v_mul_u32_u24 v115, 20, v111
    ds_write_b32 v112, v123 offset:12316
    ds_write_b32 v113, v123 offset:12316
    ds_write_b32 v114, v123 offset:12316
    ds_write_b32 v115, v123 offset:12316
    v_sub_u32 v108, v108, v104
    v_sub_u32 v109, v109, v105
    v_sub_u32 v110, v110, v106
    v_sub_u32 v111, v111, v107
    v_mul_u32_u24 v116, 20, v108
    v_mul_u32_u24 v117, 20, v109
    v_mul_u32_u24 v118, 20, v110
    v_mul_u32_u24 v119, 20, v111
    ds_write_b128 v1, v[116:119] offset:8192
    v_add_u32 v115, 127, v115
    v_and_b32 v115, -128, v115
    v_cmpx_eq_u32 vcc, 255, v0
    ds_write_b32 v123, v115 offset:12292
    s_mov_b64 exec, -1
    s_waitcnt lgkmcnt(0)
    s_barrier
    v_lshl_or_b32 v104, v104, 16, v108
    v_lshl_or_b32 v105, v105, 16, v109
    v_lshl_or_b32 v106, v106, 16, v110
    v_lshl_or_b32 v107, v107, 16, v111
    s_and_b32 s38, s33, 1
    s_lshl_b32 s38, s38, 3
    s_and_b32 s39, s33, 2
    s_lshl_b32 s39, s39, 1
    s_add_u32 s38, s38, s39
    s_add_u32 s38, s38, 130080
    v_lshl_add_u32 v120, v120, 3, s38
    ds_write_b32 v120, v104 offset:16
    ds_write_b32 v120, v105 offset:48
    ds_write_b32 v120, v106 offset:80
    ds_write_b32 v120, v107 offset:112
    s_setprio 0
Lp_skipB1:
    s_cmp_lt_u32 s33, 4
    s_cbranch_scc1 Lp_skipBB1
    s_barrier
Lp_skipBB1:
    v_mov_b32 v3, 5
    v_mov_b32 v120, 0
    ds_read_b32 v120, v120 offset:12292
    ds_add_rtn_u32 v54, v54, v3 offset:8192
    ds_add_rtn_u32 v55, v55, v3 offset:8192
    ds_add_rtn_u32 v56, v56, v3 offset:8192
    ds_add_rtn_u32 v57, v57, v3 offset:8192
    ds_add_rtn_u32 v58, v58, v3 offset:8192
    ds_add_rtn_u32 v59, v59, v3 offset:8192
    ds_add_rtn_u32 v60, v60, v3 offset:8192
    ds_add_rtn_u32 v61, v61, v3 offset:8192
    s_mov_b32 s40, 0
    buffer_store_dwordx4 v[4:7], v1, s[24:27], s40 offen sc1
    s_waitcnt lgkmcnt(4)
    v_and_b32 v124, 3, v54
    v_lshrrev_b32 v125, 20, v74
    v_mad_i32_i24 v124, v124, -4, v54
    v_add_u32 v125, 49, v125
    v_and_b32 v54, -4, v54
    v_and_b32 v74, 0xfffff, v74
    ds_write_b8 v124, v125 offset:12336
    v_and_b32 v126, 3, v55
    v_lshrrev_b32 v127, 20, v75
    v_mad_i32_i24 v126, v126, -4, v55
    v_add_u32 v127, 49, v127
    v_and_b32 v55, -4, v55
    v_and_b32 v75, 0xfffff, v75
    ds_write_b8 v126, v127 offset:12336
    v_and_b32 v124, 3, v56
    v_lshrrev_b32 v125, 20, v76
    v_mad_i32_i24 v124, v124, -4, v56
    v_add_u32 v125, 49, v125
    v_and_b32 v56, -4, v56
    v_and_b32 v76, 0xfffff, v76
    ds_write_b8 v124, v125 offset:12336
    v_and_b32 v126, 3, v57
    v_lshrrev_b32 v127, 20, v77
    v_mad_i32_i24 v126, v126, -4, v57
    v_add_u32 v127, 49, v127
    v_and_b32 v57, -4, v57
    v_and_b32 v77, 0xfffff, v77
    ds_write_b8 v126, v127 offset:12336
    ds_add_rtn_u32 v62, v62, v3 offset:8192
    ds_add_rtn_u32 v63, v63, v3 offset:8192
    ds_add_rtn_u32 v64, v64, v3 offset:8192
    ds_add_rtn_u32 v65, v65, v3 offset:8192
    s_mov_b32 s40, 15360
    buffer_store_dwordx4 v[8:11], v1, s[24:27], s40 offen sc1
    s_waitcnt lgkmcnt(8)
    v_and_b32 v124, 3, v58
    v_lshrrev_b32 v125, 20, v78
    v_mad_i32_i24 v124, v124, -4, v58
    v_add_u32 v125, 49, v125
    v_and_b32 v58, -4, v58
    v_and_b32 v78, 0xfffff, v78
    ds_write_b8 v124, v125 offset:12336
    v_and_b32 v126, 3, v59
    v_lshrrev_b32 v127, 20, v79
    v_mad_i32_i24 v126, v126, -4, v59
    v_add_u32 v127, 49, v127
    v_and_b32 v59, -4, v59
    v_and_b32 v79, 0xfffff, v79
    ds_write_b8 v126, v127 offset:12336
    v_and_b32 v124, 3, v60
    v_lshrrev_b32 v125, 20, v80
    v_mad_i32_i24 v124, v124, -4, v60
    v_add_u32 v125, 49, v125
    v_and_b32 v60, -4, v60
    v_and_b32 v80, 0xfffff, v80
    ds_write_b8 v124, v125 offset:12336
    v_and_b32 v126, 3, v61
    v_lshrrev_b32 v127, 20, v81
    v_mad_i32_i24 v126, v126, -4, v61
    v_add_u32 v127, 49, v127
    v_and_b32 v61, -4, v61
    v_and_b32 v81, 0xfffff, v81
    ds_write_b8 v126, v127 offset:12336
    ds_add_rtn_u32 v66, v66, v3 offset:8192
    ds_add_rtn_u32 v67, v67, v3 offset:8192
    ds_add_rtn_u32 v68, v68, v3 offset:8192
    ds_add_rtn_u32 v69, v69, v3 offset:8192
    s_mov_b32 s40, 30720
    buffer_store_dwordx4 v[12:15], v1, s[24:27], s40 offen sc1
    s_waitcnt lgkmcnt(8)
    v_and_b32 v124, 3, v62
    v_lshrrev_b32 v125, 20, v82
    v_mad_i32_i24 v124, v124, -4, v62
    v_add_u32 v125, 49, v125
    v_and_b32 v62, -4, v62
    v_and_b32 v82, 0xfffff, v82
    ds_write_b8 v124, v125 offset:12336
    v_and_b32 v126, 3, v63
    v_lshrrev_b32 v127, 20, v83
    v_mad_i32_i24 v126, v126, -4, v63
    v_add_u32 v127, 49, v127
    v_and_b32 v63, -4, v63
    v_and_b32 v83, 0xfffff, v83
    ds_write_b8 v126, v127 offset:12336
    v_and_b32 v124, 3, v64
    v_lshrrev_b32 v125, 20, v84
    v_mad_i32_i24 v124, v124, -4, v64
    v_add_u32 v125, 49, v125
    v_and_b32 v64, -4, v64
    v_and_b32 v84, 0xfffff, v84
    ds_write_b8 v124, v125 offset:12336
    v_and_b32 v126, 3, v65
    v_lshrrev_b32 v127, 20, v85
    v_mad_i32_i24 v126, v126, -4, v65
    v_add_u32 v127, 49, v127
    v_and_b32 v65, -4, v65
    v_and_b32 v85, 0xfffff, v85
    ds_write_b8 v126, v127 offset:12336
    ds_add_rtn_u32 v70, v70, v3 offset:8192
    ds_add_rtn_u32 v71, v71, v3 offset:8192
    ds_add_rtn_u32 v72, v72, v3 offset:8192
    ds_add_rtn_u32 v73, v73, v3 offset:8192
    s_mov_b32 s40, 46080
    buffer_store_dwordx4 v[16:19], v1, s[24:27], s40 offen sc1
    s_waitcnt lgkmcnt(8)
    v_and_b32 v124, 3, v66
    v_lshrrev_b32 v125, 20, v86
    v_mad_i32_i24 v124, v124, -4, v66
    v_add_u32 v125, 49, v125
    v_and_b32 v66, -4, v66
    v_and_b32 v86, 0xfffff, v86
    ds_write_b8 v124, v125 offset:12336
    v_and_b32 v126, 3, v67
    v_lshrrev_b32 v127, 20, v87
    v_mad_i32_i24 v126, v126, -4, v67
    v_add_u32 v127, 49, v127
    v_and_b32 v67, -4, v67
    v_and_b32 v87, 0xfffff, v87
    ds_write_b8 v126, v127 offset:12336
    v_and_b32 v124, 3, v68
    v_lshrrev_b32 v125, 20, v88
    v_mad_i32_i24 v124, v124, -4, v68
    v_add_u32 v125, 49, v125
    v_and_b32 v68, -4, v68
    v_and_b32 v88, 0xfffff, v88
    ds_write_b8 v124, v125 offset:12336
    v_and_b32 v126, 3, v69
    v_lshrrev_b32 v127, 20, v89
    v_mad_i32_i24 v126, v126, -4, v69
    v_add_u32 v127, 49, v127
    v_and_b32 v69, -4, v69
    v_and_b32 v89, 0xfffff, v89
    ds_write_b8 v126, v127 offset:12336
    s_mov_b32 s40, 61440
    buffer_store_dwordx4 v[20:23], v1, s[24:27], s40 offen sc1
    s_waitcnt lgkmcnt(4)
    v_and_b32 v124, 3, v70
    v_lshrrev_b32 v125, 20, v90
    v_mad_i32_i24 v124, v124, -4, v70
    v_add_u32 v125, 49, v125
    v_and_b32 v70, -4, v70
    v_and_b32 v90, 0xfffff, v90
    ds_write_b8 v124, v125 offset:12336
    v_and_b32 v126, 3, v71
    v_lshrrev_b32 v127, 20, v91
    v_mad_i32_i24 v126, v126, -4, v71
    v_add_u32 v127, 49, v127
    v_and_b32 v71, -4, v71
    v_and_b32 v91, 0xfffff, v91
    ds_write_b8 v126, v127 offset:12336
    v_and_b32 v124, 3, v72
    v_lshrrev_b32 v125, 20, v92
    v_mad_i32_i24 v124, v124, -4, v72
    v_add_u32 v125, 49, v125
    v_and_b32 v72, -4, v72
    v_and_b32 v92, 0xfffff, v92
    ds_write_b8 v124, v125 offset:12336
    v_and_b32 v126, 3, v73
    v_lshrrev_b32 v127, 20, v93
    v_mad_i32_i24 v126, v126, -4, v73
    v_add_u32 v127, 49, v127
    v_and_b32 v73, -4, v73
    v_and_b32 v93, 0xfffff, v93
    ds_write_b8 v126, v127 offset:12336
    v_readfirstlane_b32 s54, v120
    s_cmp_eq_u32 s33, 15
    s_cselect_b32 s54, 0, s54
    v_mov_b32 v121, 0xfff00000
    v_mov_b32 v122, 0x4effe000
    s_mov_b32 s40, 76800
    buffer_store_dwordx4 v[24:27], v1, s[24:27], s40 offen sc1
    s_waitcnt vmcnt(10)
    v_lshlrev_b32 v124, 16, v94
    v_and_b32 v125, 0xffff0000, v94
    v_mul_f32 v124, 0.15915494, v124
    v_mul_f32 v125, 0.15915494, v125
    v_fract_f32 v124, v124
    v_fract_f32 v125, v125
    v_cos_f32 v124, v124
    v_cos_f32 v125, v125
    v_fmaak_f32 v124, v124, v122, 0x49000000
    v_fmaak_f32 v125, v125, v122, 0x49000000
    v_cvt_i32_f32 v124, v124
    v_cvt_i32_f32 v125, v125
    v_sub_u32 v124, v124, v74
    v_bitop3_b32 v124, v121, v124, v74 bitop3:0xca
    ds_write_b32 v54, v124 offset:12320
    v_sub_u32 v125, v125, v75
    v_bitop3_b32 v125, v121, v125, v75 bitop3:0xca
    ds_write_b32 v55, v125 offset:12320
    v_lshlrev_b32 v126, 16, v95
    v_and_b32 v127, 0xffff0000, v95
    v_mul_f32 v126, 0.15915494, v126
    v_mul_f32 v127, 0.15915494, v127
    v_fract_f32 v126, v126
    v_fract_f32 v127, v127
    v_cos_f32 v126, v126
    v_cos_f32 v127, v127
    v_fmaak_f32 v126, v126, v122, 0x49000000
    v_fmaak_f32 v127, v127, v122, 0x49000000
    v_cvt_i32_f32 v126, v126
    v_cvt_i32_f32 v127, v127
    v_sub_u32 v126, v126, v76
    v_bitop3_b32 v126, v121, v126, v76 bitop3:0xca
    ds_write_b32 v56, v126 offset:12320
    v_sub_u32 v127, v127, v77
    v_bitop3_b32 v127, v121, v127, v77 bitop3:0xca
    ds_write_b32 v57, v127 offset:12320
    s_waitcnt vmcnt(9)
    v_lshlrev_b32 v124, 16, v96
    v_and_b32 v125, 0xffff0000, v96
    v_mul_f32 v124, 0.15915494, v124
    v_mul_f32 v125, 0.15915494, v125
    v_fract_f32 v124, v124
    v_fract_f32 v125, v125
    v_cos_f32 v124, v124
    v_cos_f32 v125, v125
    v_fmaak_f32 v124, v124, v122, 0x49000000
    v_fmaak_f32 v125, v125, v122, 0x49000000
    v_cvt_i32_f32 v124, v124
    v_cvt_i32_f32 v125, v125
    v_sub_u32 v124, v124, v78
    v_bitop3_b32 v124, v121, v124, v78 bitop3:0xca
    ds_write_b32 v58, v124 offset:12320
    v_sub_u32 v125, v125, v79
    v_bitop3_b32 v125, v121, v125, v79 bitop3:0xca
    ds_write_b32 v59, v125 offset:12320
    v_lshlrev_b32 v126, 16, v97
    v_and_b32 v127, 0xffff0000, v97
    v_mul_f32 v126, 0.15915494, v126
    v_mul_f32 v127, 0.15915494, v127
    v_fract_f32 v126, v126
    v_fract_f32 v127, v127
    v_cos_f32 v126, v126
    v_cos_f32 v127, v127
    v_fmaak_f32 v126, v126, v122, 0x49000000
    v_fmaak_f32 v127, v127, v122, 0x49000000
    v_cvt_i32_f32 v126, v126
    v_cvt_i32_f32 v127, v127
    v_sub_u32 v126, v126, v80
    v_bitop3_b32 v126, v121, v126, v80 bitop3:0xca
    ds_write_b32 v60, v126 offset:12320
    v_sub_u32 v127, v127, v81
    v_bitop3_b32 v127, v121, v127, v81 bitop3:0xca
    ds_write_b32 v61, v127 offset:12320
    s_mov_b32 s40, 92160
    buffer_store_dwordx4 v[28:31], v1, s[24:27], s40 offen sc1
    s_waitcnt vmcnt(9)
    v_lshlrev_b32 v124, 16, v98
    v_and_b32 v125, 0xffff0000, v98
    v_mul_f32 v124, 0.15915494, v124
    v_mul_f32 v125, 0.15915494, v125
    v_fract_f32 v124, v124
    v_fract_f32 v125, v125
    v_cos_f32 v124, v124
    v_cos_f32 v125, v125
    v_fmaak_f32 v124, v124, v122, 0x49000000
    v_fmaak_f32 v125, v125, v122, 0x49000000
    v_cvt_i32_f32 v124, v124
    v_cvt_i32_f32 v125, v125
    v_sub_u32 v124, v124, v82
    v_bitop3_b32 v124, v121, v124, v82 bitop3:0xca
    ds_write_b32 v62, v124 offset:12320
    v_sub_u32 v125, v125, v83
    v_bitop3_b32 v125, v121, v125, v83 bitop3:0xca
    ds_write_b32 v63, v125 offset:12320
    v_lshlrev_b32 v126, 16, v99
    v_and_b32 v127, 0xffff0000, v99
    v_mul_f32 v126, 0.15915494, v126
    v_mul_f32 v127, 0.15915494, v127
    v_fract_f32 v126, v126
    v_fract_f32 v127, v127
    v_cos_f32 v126, v126
    v_cos_f32 v127, v127
    v_fmaak_f32 v126, v126, v122, 0x49000000
    v_fmaak_f32 v127, v127, v122, 0x49000000
    v_cvt_i32_f32 v126, v126
    v_cvt_i32_f32 v127, v127
    v_sub_u32 v126, v126, v84
    v_bitop3_b32 v126, v121, v126, v84 bitop3:0xca
    ds_write_b32 v64, v126 offset:12320
    v_sub_u32 v127, v127, v85
    v_bitop3_b32 v127, v121, v127, v85 bitop3:0xca
    ds_write_b32 v65, v127 offset:12320
    s_waitcnt vmcnt(8)
    v_lshlrev_b32 v124, 16, v100
    v_and_b32 v125, 0xffff0000, v100
    v_mul_f32 v124, 0.15915494, v124
    v_mul_f32 v125, 0.15915494, v125
    v_fract_f32 v124, v124
    v_fract_f32 v125, v125
    v_cos_f32 v124, v124
    v_cos_f32 v125, v125
    v_fmaak_f32 v124, v124, v122, 0x49000000
    v_fmaak_f32 v125, v125, v122, 0x49000000
    v_cvt_i32_f32 v124, v124
    v_cvt_i32_f32 v125, v125
    v_sub_u32 v124, v124, v86
    v_bitop3_b32 v124, v121, v124, v86 bitop3:0xca
    ds_write_b32 v66, v124 offset:12320
    v_sub_u32 v125, v125, v87
    v_bitop3_b32 v125, v121, v125, v87 bitop3:0xca
    ds_write_b32 v67, v125 offset:12320
    v_lshlrev_b32 v126, 16, v101
    v_and_b32 v127, 0xffff0000, v101
    v_mul_f32 v126, 0.15915494, v126
    v_mul_f32 v127, 0.15915494, v127
    v_fract_f32 v126, v126
    v_fract_f32 v127, v127
    v_cos_f32 v126, v126
    v_cos_f32 v127, v127
    v_fmaak_f32 v126, v126, v122, 0x49000000
    v_fmaak_f32 v127, v127, v122, 0x49000000
    v_cvt_i32_f32 v126, v126
    v_cvt_i32_f32 v127, v127
    v_sub_u32 v126, v126, v88
    v_bitop3_b32 v126, v121, v126, v88 bitop3:0xca
    ds_write_b32 v68, v126 offset:12320
    v_sub_u32 v127, v127, v89
    v_bitop3_b32 v127, v121, v127, v89 bitop3:0xca
    ds_write_b32 v69, v127 offset:12320
    s_mov_b32 s40, 107520
    buffer_store_dwordx4 v[32:35], v1, s[24:27], s40 offen sc1
    s_waitcnt vmcnt(8)
    v_lshlrev_b32 v124, 16, v102
    v_and_b32 v125, 0xffff0000, v102
    v_mul_f32 v124, 0.15915494, v124
    v_mul_f32 v125, 0.15915494, v125
    v_fract_f32 v124, v124
    v_fract_f32 v125, v125
    v_cos_f32 v124, v124
    v_cos_f32 v125, v125
    v_fmaak_f32 v124, v124, v122, 0x49000000
    v_fmaak_f32 v125, v125, v122, 0x49000000
    v_cvt_i32_f32 v124, v124
    v_cvt_i32_f32 v125, v125
    v_sub_u32 v124, v124, v90
    v_bitop3_b32 v124, v121, v124, v90 bitop3:0xca
    ds_write_b32 v70, v124 offset:12320
    v_sub_u32 v125, v125, v91
    v_bitop3_b32 v125, v121, v125, v91 bitop3:0xca
    ds_write_b32 v71, v125 offset:12320
    v_lshlrev_b32 v126, 16, v103
    v_and_b32 v127, 0xffff0000, v103
    v_mul_f32 v126, 0.15915494, v126
    v_mul_f32 v127, 0.15915494, v127
    v_fract_f32 v126, v126
    v_fract_f32 v127, v127
    v_cos_f32 v126, v126
    v_cos_f32 v127, v127
    v_fmaak_f32 v126, v126, v122, 0x49000000
    v_fmaak_f32 v127, v127, v122, 0x49000000
    v_cvt_i32_f32 v126, v126
    v_cvt_i32_f32 v127, v127
    v_sub_u32 v126, v126, v92
    v_bitop3_b32 v126, v121, v126, v92 bitop3:0xca
    ds_write_b32 v72, v126 offset:12320
    v_sub_u32 v127, v127, v93
    v_bitop3_b32 v127, v121, v127, v93 bitop3:0xca
    ds_write_b32 v73, v127 offset:12320
    v_add_u32 v120, 0x10000, v1
    s_waitcnt lgkmcnt(0)
    s_barrier
    ds_read_b128 v[54:57], v1 offset:12320
    ds_read_b128 v[58:61], v1 offset:27680
    ds_read_b128 v[62:65], v1 offset:43040
    ds_read_b128 v[66:69], v1 offset:58400
    ds_read_b128 v[70:73], v120 offset:8224
    ds_read_b128 v[74:77], v120 offset:23584
    ds_read_b128 v[78:81], v120 offset:38944
    ds_read_b128 v[82:85], v120 offset:54304
    v_add_u32 v121, 130080, v1
    ds_read_b128 v[104:107], v121
    s_waitcnt lgkmcnt(8)
    s_mov_b32 s40, 0
    buffer_store_dwordx4 v[54:57], v1, s[52:55], s40 offen sc1
    s_waitcnt lgkmcnt(7)
    s_mov_b32 s40, 15360
    buffer_store_dwordx4 v[58:61], v1, s[52:55], s40 offen sc1
    s_waitcnt lgkmcnt(6)
    s_mov_b32 s40, 30720
    buffer_store_dwordx4 v[62:65], v1, s[52:55], s40 offen sc1
    s_waitcnt lgkmcnt(5)
    s_mov_b32 s40, 46080
    buffer_store_dwordx4 v[66:69], v1, s[52:55], s40 offen sc1
    s_waitcnt lgkmcnt(4)
    s_mov_b32 s40, 61440
    buffer_store_dwordx4 v[70:73], v1, s[52:55], s40 offen sc1
    s_waitcnt lgkmcnt(3)
    s_mov_b32 s40, 76800
    buffer_store_dwordx4 v[74:77], v1, s[52:55], s40 offen sc1
    s_waitcnt lgkmcnt(2)
    s_mov_b32 s40, 92160
    buffer_store_dwordx4 v[78:81], v1, s[52:55], s40 offen sc1
    s_waitcnt lgkmcnt(1)
    s_mov_b32 s40, 107520
    buffer_store_dwordx4 v[82:85], v1, s[52:55], s40 offen sc1
    s_cmp_ge_u32 s33, 8
    s_cbranch_scc1 Lp_end
    s_lshl_b32 s39, s2, 13
    s_waitcnt lgkmcnt(0)
    buffer_store_dwordx4 v[104:107], v1, s[28:31], s39 offen sc1
Lp_end:
    s_endpgm
.globl c_kernel
.p2align 8
.type c_kernel,@function
c_kernel:
    s_cmp_ge_u32 s2, 256
    s_cbranch_scc1 Lc_end
    s_setprio 3
    s_load_dwordx2 s[10:11], s[0:1], 104
    s_load_dwordx2 s[64:65], s[0:1], 0
    s_load_dwordx2 s[66:67], s[0:1], 24
    s_load_dwordx4 s[68:71], s[0:1], 80
    s_and_b32 s3, s2, 7
    s_lshl_b32 s3, s3, 5
    s_lshr_b32 s4, s2, 3
    s_or_b32 s3, s3, s4
    s_lshl_b32 s3, s3, 2
    v_lshrrev_b32 v106, 6, v0
    v_and_b32 v1, 63, v0
    v_readfirstlane_b32 s6, v106
    v_lshlrev_b32 v10, 2, v1
    s_mul_i32 s7, s6, 3856
    s_add_u32 s7, s7, 54528
    v_lshl_add_u32 v106, v1, 4, s7
    v_add_u32 v107, s7, v10
    s_cmp_ge_u32 s6, 13
    s_cbranch_scc1 Lc_nocnt
    s_mul_i32 s4, s6, 43
    s_lshr_b32 s4, s4, 7
    s_mul_i32 s5, s4, 192
    s_bitcmp1_b32 s4, 0
    s_cselect_b32 s4, 0, 12480
    s_add_u32 s4, s4, 13632
    v_subrev_u32 v114, s5, v0
    v_mul_u32_u24 v114, 65, v114
    v_add_u32 v114, s4, v114
    v_cmpx_eq_u32 vcc, s5, v0
    v_mov_b32 v114, 0x9000a800
    s_mov_b64 exec, -1
    v_cmpx_eq_u32 vcc, 770, v0
    v_mov_b32 v114, 154368
    s_mov_b64 exec, -1
    v_cmpx_eq_u32 vcc, 771, v0
    v_mov_b32 v114, 0
    s_mov_b64 exec, -1
    v_lshlrev_b32 v115, 2, v0
    ds_write_b32 v115, v114 offset:0
Lc_nocnt:
    v_mov_b32 v102, 20
    v_mov_b32 v103, 20
    v_mov_b32 v104, 20
    v_mov_b32 v105, 20
    s_waitcnt lgkmcnt(0)
    s_mov_b32 s20, s10
    s_and_b32 s21, s11, 0xffff
    s_mov_b32 s22, 268435456
    s_mov_b32 s23, 0x00020000
    s_lshl_b32 s4, s6, 5
    v_and_or_b32 v114, v1, 31, s4
    v_lshrrev_b32 v115, 1, v114
    v_lshlrev_b32 v115, 13, v115
    v_lshlrev_b32 v116, 4, v114
    v_and_or_b32 v115, v116, 16, v115
    v_lshrrev_b32 v116, 2, v1
    v_and_or_b32 v115, v116, 8, v115
    s_lshl_b32 s4, s3, 3
    buffer_load_dwordx2 v[110:111], v115, s[20:23], s4 offen
    v_mul_u32_u24 v108, 117760, v114
    s_mov_b32 s28, s66
    s_and_b32 s29, s67, 0xffff
    s_mov_b32 s30, 640000
    s_mov_b32 s31, 0x00020000
    s_mul_i32 s62, s3, 2500
    s_and_b32 s63, s62, -128
    s_lshr_b32 s4, s63, 2
    v_lshlrev_b32 v114, 1, v0
    buffer_load_ushort v96, v114, s[28:31], s4 offen
    buffer_load_ushort v97, v114, s[28:31], s4 offen offset:2048
    v_lshlrev_b32 v114, 4, v1
    s_mov_b32 s4, 7340032
    buffer_load_dwordx4 v[98:101], v114, s[20:23], s4 offen
    s_mov_b32 s28, s64
    s_and_b32 s29, s65, 0xffff
    s_mov_b32 s30, 2560000
    s_mov_b32 s31, 0x00020000
    s_movk_i32 s4, 10000
    v_lshl_add_u32 v32, v0, 3, s63
    v_mov_b32 v33, v32
    v_subrev_u32 v122, s62, v32
    v_cmp_gt_u32 vcc, s4, v122
    s_nop 1
    v_cndmask_b32 v32, -1, v32, vcc
    buffer_load_dwordx2 v[30:31], v32, s[28:31], 0 offen
    v_add_u32 v36, 8192, v33
    v_subrev_u32 v122, s62, v36
    v_cmp_gt_u32 vcc, s4, v122
    s_nop 1
    v_cndmask_b32 v36, -1, v36, vcc
    buffer_load_dwordx2 v[34:35], v36, s[28:31], 0 offen
    s_mov_b32 s28, s70
    s_and_b32 s29, s71, 0xffff
    s_mov_b32 s30, 2560000
    s_mov_b32 s31, 0x00020000
    s_barrier
    ds_write_b128 v106, v[102:105] offset:0
    ds_write_b128 v106, v[102:105] offset:1024
    ds_write_b128 v106, v[102:105] offset:2048
    ds_write_b32 v107, v102 offset:3072
    ds_write_b32 v107, v102 offset:3328
    ds_write_b32 v107, v102 offset:3584
    s_add_u32 s12, s10, 3145728
    s_addc_u32 s13, s11, 0
    s_and_b32 s13, s13, 0xffff
    s_or_b32 s13, s13, 524288
    s_mov_b32 s14, 524288
    s_mov_b32 s15, 0x00020000
    v_add_u32 v108, 3233808384, v108
    s_waitcnt vmcnt(3)
    v_lshlrev_b32 v96, 5, v96
    v_lshlrev_b32 v97, 5, v97
    s_mov_b32 s24, 8388608
    buffer_load_dwordx4 v[88:91], v96, s[20:23], s24 offen
    buffer_load_dwordx4 v[92:95], v96, s[20:23], s24 offen offset:16
    s_cmp_ge_u32 s6, 4
    s_cbranch_scc1 Lc_g2skip
    buffer_load_dwordx4 v[70:73], v97, s[20:23], s24 offen
    buffer_load_dwordx4 v[74:77], v97, s[20:23], s24 offen offset:16
Lc_g2skip:
    v_and_b32 v114, 0xffff, v110
    v_lshrrev_b32 v112, 16, v110
    v_mov_b32 v110, v112
    v_and_b32 v115, 0xffff, v111
    v_lshrrev_b32 v113, 16, v111
    v_mov_b32 v111, v113
    v_add_u32_dpp v110, v110, v110 row_shr:1 row_mask:0xf bank_mask:0xf bound_ctrl:0
    s_nop 0
    v_add_u32_dpp v111, v111, v111 row_shr:1 row_mask:0xf bank_mask:0xf bound_ctrl:0
    v_add_u32_dpp v110, v110, v110 row_shr:2 row_mask:0xf bank_mask:0xf bound_ctrl:0
    s_nop 0
    v_add_u32_dpp v111, v111, v111 row_shr:2 row_mask:0xf bank_mask:0xf bound_ctrl:0
    v_add_u32_dpp v110, v110, v110 row_shr:4 row_mask:0xf bank_mask:0xf bound_ctrl:0
    s_nop 0
    v_add_u32_dpp v111, v111, v111 row_shr:4 row_mask:0xf bank_mask:0xf bound_ctrl:0
    v_add_u32_dpp v110, v110, v110 row_shr:8 row_mask:0xf bank_mask:0xf bound_ctrl:0
    s_nop 0
    v_add_u32_dpp v111, v111, v111 row_shr:8 row_mask:0xf bank_mask:0xf bound_ctrl:0
    v_add_u32_dpp v110, v110, v110 row_bcast:15 row_mask:0xa bank_mask:0xf
    s_nop 0
    v_add_u32_dpp v111, v111, v111 row_bcast:15 row_mask:0xa bank_mask:0xf
    v_sub_u32 v112, v110, v112
    v_sub_u32 v113, v111, v113
    v_readlane_b32 s16, v110, 31
    v_readlane_b32 s17, v110, 63
    v_readlane_b32 s18, v111, 31
    v_readlane_b32 s19, v111, 63
    v_sub_u32 v114, v114, v112
    v_sub_u32 v115, v115, v113
    v_mad_i32_i24 v109, v115, 20, v108
    v_mad_i32_i24 v108, v114, 20, v108
    v_mov_b32 v117, 0
    v_mov_b32 v118, 192
    s_mov_b32 exec_lo, 0
    v_mov_b32 v117, 192
    v_mov_b32 v118, 256
    s_mov_b32 exec_lo, -1
    v_min_u32 v114, v118, v112
    v_min_u32 v115, v118, v110
    v_mul_u32_u24 v116, 20, v117
    v_sub_u32 v116, v108, v116
    v_add_u32 v114, v114, v117
    v_add_u32 v115, v115, v117
    v_lshl_add_u32 v114, v114, 2, s7
    v_lshl_add_u32 v115, v115, 2, s7
    ds_add_u32 v114, v116
    ds_sub_u32 v115, v116
    v_mov_b32 v117, 448
    v_mov_b32 v118, 256
    s_mov_b32 exec_lo, 0
    v_mov_b32 v117, 704
    v_mov_b32 v118, 256
    s_mov_b32 exec_lo, -1
    v_min_u32 v114, v118, v113
    v_min_u32 v115, v118, v111
    v_mul_u32_u24 v116, 20, v117
    v_sub_u32 v116, v109, v116
    v_add_u32 v114, v114, v117
    v_add_u32 v115, v115, v117
    v_lshl_add_u32 v114, v114, 2, s7
    v_lshl_add_u32 v115, v115, 2, s7
    ds_add_u32 v114, v116
    ds_sub_u32 v115, v116
    ds_read_b32 v78, v107 offset:0
    ds_read_b32 v79, v107 offset:256
    ds_read_b32 v80, v107 offset:512
    s_mov_b32 s5, 0x3fffffec
    s_mov_b32 s9, 0
    s_cmp_gt_u32 s16, 192
    s_cselect_b32 s9, 1, s9
    s_cmp_gt_u32 s17, 256
    s_cselect_b32 s9, 1, s9
    s_cmp_gt_u32 s18, 256
    s_cselect_b32 s9, 1, s9
    s_cmp_gt_u32 s19, 256
    s_cselect_b32 s9, 1, s9
    s_waitcnt lgkmcnt(0)
    v_add_u32_dpp v78, v78, v78 row_shr:1 row_mask:0xf bank_mask:0xf bound_ctrl:0
    v_add_u32_dpp v79, v79, v79 row_shr:1 row_mask:0xf bank_mask:0xf bound_ctrl:0
    v_add_u32_dpp v80, v80, v80 row_shr:1 row_mask:0xf bank_mask:0xf bound_ctrl:0
    v_add_u32_dpp v78, v78, v78 row_shr:2 row_mask:0xf bank_mask:0xf bound_ctrl:0
    v_add_u32_dpp v79, v79, v79 row_shr:2 row_mask:0xf bank_mask:0xf bound_ctrl:0
    v_add_u32_dpp v80, v80, v80 row_shr:2 row_mask:0xf bank_mask:0xf bound_ctrl:0
    v_add_u32_dpp v78, v78, v78 row_shr:4 row_mask:0xf bank_mask:0xf bound_ctrl:0
    v_add_u32_dpp v79, v79, v79 row_shr:4 row_mask:0xf bank_mask:0xf bound_ctrl:0
    v_add_u32_dpp v80, v80, v80 row_shr:4 row_mask:0xf bank_mask:0xf bound_ctrl:0
    v_add_u32_dpp v78, v78, v78 row_shr:8 row_mask:0xf bank_mask:0xf bound_ctrl:0
    v_add_u32_dpp v79, v79, v79 row_shr:8 row_mask:0xf bank_mask:0xf bound_ctrl:0
    v_add_u32_dpp v80, v80, v80 row_shr:8 row_mask:0xf bank_mask:0xf bound_ctrl:0
    v_add_u32_dpp v78, v78, v78 row_bcast:15 row_mask:0xa bank_mask:0xf
    v_add_u32_dpp v79, v79, v79 row_bcast:15 row_mask:0xa bank_mask:0xf
    v_add_u32_dpp v80, v80, v80 row_bcast:15 row_mask:0xa bank_mask:0xf
    v_add_u32_dpp v78, v78, v78 row_bcast:31 row_mask:0xc bank_mask:0xf
    v_add_u32_dpp v79, v79, v79 row_bcast:31 row_mask:0xc bank_mask:0xf
    v_add_u32_dpp v80, v80, v80 row_bcast:31 row_mask:0xc bank_mask:0xf
    v_readlane_b32 s56, v78, 63
    v_readlane_b32 s57, v79, 63
    v_readlane_b32 s58, v80, 63
    v_add_u32 v78, s5, v78
    s_add_u32 s5, s5, s56
    v_add_u32 v79, s5, v79
    s_add_u32 s5, s5, s57
    v_add_u32 v80, s5, v80
    s_add_u32 s5, s5, s58
    buffer_load_dwordx3 v[40:42], v78, s[20:23], 0 offen
    buffer_load_dwordx2 v[44:45], v78, s[20:23], 0 offen offset:12
    buffer_load_dwordx3 v[50:52], v79, s[20:23], 0 offen
    buffer_load_dwordx2 v[54:55], v79, s[20:23], 0 offen offset:12
    buffer_load_dwordx3 v[60:62], v80, s[20:23], 0 offen
    buffer_load_dwordx2 v[64:65], v80, s[20:23], 0 offen offset:12
    s_setprio 1
    ds_read_b32 v18, v107 offset:768
    ds_read_b32 v19, v107 offset:1024
    ds_read_b32 v20, v107 offset:1280
    ds_read_b32 v21, v107 offset:1536
    ds_read_b32 v22, v107 offset:1792
    ds_read_b32 v23, v107 offset:2048
    ds_read_b32 v24, v107 offset:2304
    ds_read_b32 v25, v107 offset:2560
    ds_read_b32 v26, v107 offset:2816
    ds_read_b32 v27, v107 offset:3072
    ds_read_b32 v28, v107 offset:3328
    ds_read_b32 v29, v107 offset:3584
    s_load_dwordx8 s[72:79], s[68:69], 0
    s_mul_i32 s4, s6, 260
    v_add_u32 v12, s4, v10
    v_add_u32 v13, 54528, v12
    v_add_u32 v12, 104448, v12
    s_lshl_b32 s4, s6, 2
    v_lshl_add_u32 v9, v1, 6, s4
    v_mov_b32 v2, 4
    v_mov_b32 v3, 0
    v_mov_b32 v7, 0x1200300c
    v_mov_b32 v11, 0x10001
    s_mov_b32 s25, 4194304
    s_mul_i32 s32, s6, 3584
    s_waitcnt vmcnt(10)
    v_min3_u32 v102, v98, v99, v100
    v_max3_u32 v98, v98, v99, v100
    v_min_u32 v102, v102, v101
    v_max_u32 v98, v98, v101
    v_not_b32 v102, v102
    s_nop 0
    v_max_u32_dpp v98, v98, v98 row_shr:1 row_mask:0xf bank_mask:0xf bound_ctrl:0
    v_max_u32_dpp v102, v102, v102 row_shr:1 row_mask:0xf bank_mask:0xf bound_ctrl:0
    s_nop 0
    v_max_u32_dpp v98, v98, v98 row_shr:2 row_mask:0xf bank_mask:0xf bound_ctrl:0
    v_max_u32_dpp v102, v102, v102 row_shr:2 row_mask:0xf bank_mask:0xf bound_ctrl:0
    s_nop 0
    v_max_u32_dpp v98, v98, v98 row_shr:4 row_mask:0xf bank_mask:0xf bound_ctrl:0
    v_max_u32_dpp v102, v102, v102 row_shr:4 row_mask:0xf bank_mask:0xf bound_ctrl:0
    s_nop 0
    v_max_u32_dpp v98, v98, v98 row_shr:8 row_mask:0xf bank_mask:0xf bound_ctrl:0
    v_max_u32_dpp v102, v102, v102 row_shr:8 row_mask:0xf bank_mask:0xf bound_ctrl:0
    s_nop 0
    v_max_u32_dpp v98, v98, v98 row_bcast:15 row_mask:0xa bank_mask:0xf
    v_max_u32_dpp v102, v102, v102 row_bcast:15 row_mask:0xa bank_mask:0xf
    s_nop 0
    v_max_u32_dpp v98, v98, v98 row_bcast:31 row_mask:0xc bank_mask:0xf
    v_max_u32_dpp v102, v102, v102 row_bcast:31 row_mask:0xc bank_mask:0xf
    v_readlane_b32 s27, v98, 63
    v_readlane_b32 s4, v102, 63
    s_lshr_b32 s27, s27, 23
    s_not_b32 s4, s4
    s_lshr_b32 s4, s4, 23
    s_add_u32 s4, s4, 8
    s_min_u32 s4, s4, 250
    s_cmp_gt_u32 s27, s4
    s_cselect_b32 s9, 1, s9
    s_add_u32 s27, s27, 2
    s_min_u32 s27, s27, 254
    s_lshl_b32 s4, s27, 23
    s_or_b32 s4, s4, 0x400000
    v_mov_b32 v6, s4
    v_sub_u32 v4, 0, v6
    v_not_b32 v5, v6
    s_sub_u32 s27, s27, 150
    s_waitcnt lgkmcnt(0)
    v_add_u32_dpp v18, v18, v18 row_shr:1 row_mask:0xf bank_mask:0xf bound_ctrl:0
    v_add_u32_dpp v19, v19, v19 row_shr:1 row_mask:0xf bank_mask:0xf bound_ctrl:0
    v_add_u32_dpp v20, v20, v20 row_shr:1 row_mask:0xf bank_mask:0xf bound_ctrl:0
    v_add_u32_dpp v21, v21, v21 row_shr:1 row_mask:0xf bank_mask:0xf bound_ctrl:0
    v_add_u32_dpp v18, v18, v18 row_shr:2 row_mask:0xf bank_mask:0xf bound_ctrl:0
    v_add_u32_dpp v19, v19, v19 row_shr:2 row_mask:0xf bank_mask:0xf bound_ctrl:0
    v_add_u32_dpp v20, v20, v20 row_shr:2 row_mask:0xf bank_mask:0xf bound_ctrl:0
    v_add_u32_dpp v21, v21, v21 row_shr:2 row_mask:0xf bank_mask:0xf bound_ctrl:0
    v_add_u32_dpp v18, v18, v18 row_shr:4 row_mask:0xf bank_mask:0xf bound_ctrl:0
    v_add_u32_dpp v19, v19, v19 row_shr:4 row_mask:0xf bank_mask:0xf bound_ctrl:0
    v_add_u32_dpp v20, v20, v20 row_shr:4 row_mask:0xf bank_mask:0xf bound_ctrl:0
    v_add_u32_dpp v21, v21, v21 row_shr:4 row_mask:0xf bank_mask:0xf bound_ctrl:0
    v_add_u32_dpp v18, v18, v18 row_shr:8 row_mask:0xf bank_mask:0xf bound_ctrl:0
    v_add_u32_dpp v19, v19, v19 row_shr:8 row_mask:0xf bank_mask:0xf bound_ctrl:0
    v_add_u32_dpp v20, v20, v20 row_shr:8 row_mask:0xf bank_mask:0xf bound_ctrl:0
    v_add_u32_dpp v21, v21, v21 row_shr:8 row_mask:0xf bank_mask:0xf bound_ctrl:0
    v_add_u32_dpp v18, v18, v18 row_bcast:15 row_mask:0xa bank_mask:0xf
    v_add_u32_dpp v19, v19, v19 row_bcast:15 row_mask:0xa bank_mask:0xf
    v_add_u32_dpp v20, v20, v20 row_bcast:15 row_mask:0xa bank_mask:0xf
    v_add_u32_dpp v21, v21, v21 row_bcast:15 row_mask:0xa bank_mask:0xf
    v_add_u32_dpp v18, v18, v18 row_bcast:31 row_mask:0xc bank_mask:0xf
    v_add_u32_dpp v19, v19, v19 row_bcast:31 row_mask:0xc bank_mask:0xf
    v_add_u32_dpp v20, v20, v20 row_bcast:31 row_mask:0xc bank_mask:0xf
    v_add_u32_dpp v21, v21, v21 row_bcast:31 row_mask:0xc bank_mask:0xf
    v_readlane_b32 s56, v18, 63
    v_readlane_b32 s57, v19, 63
    v_readlane_b32 s58, v20, 63
    v_readlane_b32 s59, v21, 63
    v_add_u32 v18, s5, v18
    s_add_u32 s5, s5, s56
    v_add_u32 v19, s5, v19
    s_add_u32 s5, s5, s57
    v_add_u32 v20, s5, v20
    s_add_u32 s5, s5, s58
    v_add_u32 v21, s5, v21
    s_add_u32 s5, s5, s59
    s_setprio 2
    s_sub_u32 s26, s16, 0
    s_waitcnt vmcnt(4)
    v_lshlrev_b32_sdwa v46, 2, v45 dst_sel:DWORD dst_unused:UNUSED_PAD src0_sel:DWORD src1_sel:BYTE_0
    v_lshlrev_b32_sdwa v47, 2, v45 dst_sel:DWORD dst_unused:UNUSED_PAD src0_sel:DWORD src1_sel:BYTE_1
    v_lshlrev_b32_sdwa v48, 2, v45 dst_sel:DWORD dst_unused:UNUSED_PAD src0_sel:DWORD src1_sel:BYTE_2
    v_lshlrev_b32_sdwa v49, 2, v45 dst_sel:DWORD dst_unused:UNUSED_PAD src0_sel:DWORD src1_sel:BYTE_3
    v_cmpx_gt_i32_e64 s[36:37], s26, v1
    ds_add_rtn_u32 v46, v46, v11 offset:0
    ds_add_rtn_u32 v47, v47, v11 offset:0
    ds_add_rtn_u32 v48, v48, v11 offset:0
    ds_add_rtn_u32 v49, v49, v11 offset:0
    s_mov_b64 exec, -1
    s_sub_u32 s26, s16, 64
    s_waitcnt vmcnt(2)
    v_lshlrev_b32_sdwa v56, 2, v55 dst_sel:DWORD dst_unused:UNUSED_PAD src0_sel:DWORD src1_sel:BYTE_0
    v_lshlrev_b32_sdwa v57, 2, v55 dst_sel:DWORD dst_unused:UNUSED_PAD src0_sel:DWORD src1_sel:BYTE_1
    v_lshlrev_b32_sdwa v58, 2, v55 dst_sel:DWORD dst_unused:UNUSED_PAD src0_sel:DWORD src1_sel:BYTE_2
    v_lshlrev_b32_sdwa v59, 2, v55 dst_sel:DWORD dst_unused:UNUSED_PAD src0_sel:DWORD src1_sel:BYTE_3
    v_cmpx_gt_i32_e64 s[38:39], s26, v1
    ds_add_rtn_u32 v56, v56, v11 offset:0
    ds_add_rtn_u32 v57, v57, v11 offset:0
    ds_add_rtn_u32 v58, v58, v11 offset:0
    ds_add_rtn_u32 v59, v59, v11 offset:0
    s_mov_b64 exec, -1
    s_waitcnt lgkmcnt(4)
    v_lshlrev_b32_sdwa v122, 2, v46 dst_sel:DWORD dst_unused:UNUSED_PAD src0_sel:DWORD src1_sel:WORD_0
    v_lshlrev_b32_sdwa v123, 2, v47 dst_sel:DWORD dst_unused:UNUSED_PAD src0_sel:DWORD src1_sel:WORD_0
    v_lshlrev_b32_sdwa v124, 2, v48 dst_sel:DWORD dst_unused:UNUSED_PAD src0_sel:DWORD src1_sel:WORD_0
    v_lshlrev_b32_sdwa v125, 2, v49 dst_sel:DWORD dst_unused:UNUSED_PAD src0_sel:DWORD src1_sel:WORD_0
    s_mov_b64 exec, s[36:37]
    v_cmpx_gt_i32_e64 s[80:81], s25, v46
    ds_write_b32 v122, v40
    s_mov_b64 exec, s[36:37]
    v_cmpx_gt_i32_e64 s[82:83], s25, v47
    ds_write_b32 v123, v41
    s_mov_b64 exec, s[36:37]
    v_cmpx_gt_i32_e64 s[84:85], s25, v48
    ds_write_b32 v124, v42
    s_mov_b64 exec, s[36:37]
    v_cmpx_gt_i32_e64 s[86:87], s25, v49
    ds_write_b32 v125, v44
    s_and_b64 s[88:89], s[80:81], s[82:83]
    s_and_b64 exec, exec, s[84:85]
    s_and_b64 s[88:89], s[88:89], exec
    s_cmp_eq_u64 s[88:89], s[36:37]
    s_cbranch_scc1 Lc_no_1
    s_mov_b64 exec, s[36:37]
    s_movk_i32 s90, 0
    s_call_b64 s[88:89], Lc_ovf40
Lc_no_1:
    s_mov_b64 exec, -1
    s_sub_u32 s26, s16, 128
    s_cmp_le_i32 s26, 0
    s_cbranch_scc1 Lc_rare_2
    s_waitcnt vmcnt(0)
    v_lshlrev_b32_sdwa v66, 2, v65 dst_sel:DWORD dst_unused:UNUSED_PAD src0_sel:DWORD src1_sel:BYTE_0
    v_lshlrev_b32_sdwa v67, 2, v65 dst_sel:DWORD dst_unused:UNUSED_PAD src0_sel:DWORD src1_sel:BYTE_1
    v_lshlrev_b32_sdwa v68, 2, v65 dst_sel:DWORD dst_unused:UNUSED_PAD src0_sel:DWORD src1_sel:BYTE_2
    v_lshlrev_b32_sdwa v69, 2, v65 dst_sel:DWORD dst_unused:UNUSED_PAD src0_sel:DWORD src1_sel:BYTE_3
    v_cmpx_gt_i32_e64 s[40:41], s26, v1
    ds_add_rtn_u32 v66, v66, v11 offset:0
    ds_add_rtn_u32 v67, v67, v11 offset:0
    ds_add_rtn_u32 v68, v68, v11 offset:0
    ds_add_rtn_u32 v69, v69, v11 offset:0
    s_mov_b64 exec, -1
Lc_rare_2:
    s_waitcnt lgkmcnt(4)
    v_lshlrev_b32_sdwa v122, 2, v56 dst_sel:DWORD dst_unused:UNUSED_PAD src0_sel:DWORD src1_sel:WORD_0
    v_lshlrev_b32_sdwa v123, 2, v57 dst_sel:DWORD dst_unused:UNUSED_PAD src0_sel:DWORD src1_sel:WORD_0
    v_lshlrev_b32_sdwa v124, 2, v58 dst_sel:DWORD dst_unused:UNUSED_PAD src0_sel:DWORD src1_sel:WORD_0
    v_lshlrev_b32_sdwa v125, 2, v59 dst_sel:DWORD dst_unused:UNUSED_PAD src0_sel:DWORD src1_sel:WORD_0
    s_mov_b64 exec, s[38:39]
    v_cmpx_gt_i32_e64 s[80:81], s25, v56
    ds_write_b32 v122, v50
    s_mov_b64 exec, s[38:39]
    v_cmpx_gt_i32_e64 s[82:83], s25, v57
    ds_write_b32 v123, v51
    s_mov_b64 exec, s[38:39]
    v_cmpx_gt_i32_e64 s[84:85], s25, v58
    ds_write_b32 v124, v52
    s_mov_b64 exec, s[38:39]
    v_cmpx_gt_i32_e64 s[86:87], s25, v59
    ds_write_b32 v125, v54
    s_and_b64 s[88:89], s[80:81], s[82:83]
    s_and_b64 exec, exec, s[84:85]
    s_and_b64 s[88:89], s[88:89], exec
    s_cmp_eq_u64 s[88:89], s[38:39]
    s_cbranch_scc1 Lc_no_3
    s_mov_b64 exec, s[38:39]
    s_movk_i32 s90, 0
    s_call_b64 s[88:89], Lc_ovf50
Lc_no_3:
    s_mov_b64 exec, -1
    s_cmp_le_u32 s16, 128
    s_cbranch_scc1 Lc_rare_4
    s_waitcnt lgkmcnt(4)
    v_lshlrev_b32_sdwa v122, 2, v66 dst_sel:DWORD dst_unused:UNUSED_PAD src0_sel:DWORD src1_sel:WORD_0
    v_lshlrev_b32_sdwa v123, 2, v67 dst_sel:DWORD dst_unused:UNUSED_PAD src0_sel:DWORD src1_sel:WORD_0
    v_lshlrev_b32_sdwa v124, 2, v68 dst_sel:DWORD dst_unused:UNUSED_PAD src0_sel:DWORD src1_sel:WORD_0
    v_lshlrev_b32_sdwa v125, 2, v69 dst_sel:DWORD dst_unused:UNUSED_PAD src0_sel:DWORD src1_sel:WORD_0
    s_mov_b64 exec, s[40:41]
    v_cmpx_gt_i32_e64 s[80:81], s25, v66
    ds_write_b32 v122, v60
    s_mov_b64 exec, s[40:41]
    v_cmpx_gt_i32_e64 s[82:83], s25, v67
    ds_write_b32 v123, v61
    s_mov_b64 exec, s[40:41]
    v_cmpx_gt_i32_e64 s[84:85], s25, v68
    ds_write_b32 v124, v62
    s_mov_b64 exec, s[40:41]
    v_cmpx_gt_i32_e64 s[86:87], s25, v69
    ds_write_b32 v125, v64
    s_and_b64 s[88:89], s[80:81], s[82:83]
    s_and_b64 exec, exec, s[84:85]
    s_and_b64 s[88:89], s[88:89], exec
    s_cmp_eq_u64 s[88:89], s[40:41]
    s_cbranch_scc1 Lc_no_5
    s_mov_b64 exec, s[40:41]
    s_movk_i32 s90, 0
    s_call_b64 s[88:89], Lc_ovf60
Lc_no_5:
    s_mov_b64 exec, -1
Lc_rare_4:
    buffer_load_dwordx3 v[40:42], v18, s[20:23], 0 offen
    buffer_load_dwordx2 v[44:45], v18, s[20:23], 0 offen offset:12
    buffer_load_dwordx3 v[50:52], v19, s[20:23], 0 offen
    buffer_load_dwordx2 v[54:55], v19, s[20:23], 0 offen offset:12
    v_lshlrev_b32 v122, 4, v0
    v_lshlrev_b32 v123, 3, v0
    v_mov_b32 v14, v94
    v_mov_b32 v15, v95
    ds_write_b128 v122, v[88:91] offset:3328
    ds_write_b64 v123, v[92:93] offset:23808
    v_mov_b32 v16, v76
    v_mov_b32 v17, v77
    s_cmp_ge_u32 s6, 4
    s_cbranch_scc1 Lc_g3skip
    ds_write_b128 v122, v[70:73] offset:19712
    ds_write_b64 v123, v[74:75] offset:32000
Lc_g3skip:
    v_mov_b32 v102, 0x40000000
    v_mov_b32 v103, 0x40000000
    v_mov_b32 v104, 0x40000000
    v_mov_b32 v105, 0x40000000
    ds_write_b128 v122, v[102:105] offset:34048
    v_lshlrev_b32 v122, 2, v0
    ds_write_b32 v122, v102 offset:50432
    v_mov_b32 v88, 0
    v_mov_b32 v89, 0
    v_mov_b32 v90, 0
    v_mov_b32 v91, 0
    v_mov_b32 v92, 0
    v_mov_b32 v93, 0
    v_mov_b32 v94, 0
    v_mov_b32 v95, 0
    s_waitcnt lgkmcnt(0)
    s_waitcnt lgkmcnt(0)
    s_barrier
    s_setprio 3
    ds_read_b32 v8, v9 offset:0
    ds_read_b32 v72, v12 offset:12480
    ds_read_b32 v73, v12 offset:16640
    ds_read_b32 v74, v12 offset:20800
    ds_read_b32 v75, v12 offset:24960
    s_waitcnt lgkmcnt(3)
    v_ashrrev_i32 v8, 16, v8
    v_med3_i32 v8, v8, 0, 64
    s_nop 0
    v_readlane_b32 s33, v8, 3
    v_and_b32 v78, 0x1ff, v72
    s_add_u32 s4, s32, 172032
    s_bfm_b64 exec, s33, 0
    s_bitcmp1_b32 s33, 6
    s_cselect_b64 exec, -1, exec
    s_mov_b64 s[46:47], exec
    buffer_load_dwordx2 v[78:79], v78, s[12:15], s4 idxen
    s_mov_b64 exec, -1
    s_waitcnt lgkmcnt(2)
    v_readlane_b32 s33, v8, 4
    v_and_b32 v80, 0x1ff, v73
    s_add_u32 s4, s32, 229376
    s_bfm_b64 exec, s33, 0
    s_bitcmp1_b32 s33, 6
    s_cselect_b64 exec, -1, exec
    s_mov_b64 s[48:49], exec
    buffer_load_dwordx2 v[80:81], v80, s[12:15], s4 idxen
    s_mov_b64 exec, -1
    s_waitcnt lgkmcnt(1)
    v_readlane_b32 s33, v8, 5
    v_and_b32 v82, 0x1ff, v74
    s_add_u32 s4, s32, 286720
    s_bfm_b64 exec, s33, 0
    s_bitcmp1_b32 s33, 6
    s_cselect_b64 exec, -1, exec
    s_mov_b64 s[50:51], exec
    buffer_load_dwordx2 v[82:83], v82, s[12:15], s4 idxen
    s_mov_b64 exec, s[46:47]
    v_lshrrev_b32 v102, 6, v72
    v_cvt_f32_i32 v103, v72
    v_and_b32 v102, 0x3ff8, v102
    v_add_u32 v105, v102, v102
    ds_read_b64 v[100:101], v102 offset:23808
    ds_read_b128 v[96:99], v105 offset:3328
    v_fmaak_f32 v105, v103, v103, 0xddffc004
    v_fmaak_f32 v104, v105, v7, 0xb0001002
    v_mul_f32 v104, v104, v103
    v_cvt_pk_bf16_f32 v103, v103, v105
    s_mov_b64 exec, s[48:49]
    v_lshrrev_b32 v112, 6, v73
    v_cvt_f32_i32 v113, v73
    v_and_b32 v112, 0x3ff8, v112
    v_add_u32 v115, v112, v112
    ds_read_b64 v[110:111], v112 offset:23808
    ds_read_b128 v[106:109], v115 offset:3328
    v_fmaak_f32 v115, v113, v113, 0xddffc004
    v_fmaak_f32 v114, v115, v7, 0xb0001002
    v_mul_f32 v114, v114, v113
    v_cvt_pk_bf16_f32 v113, v113, v115
    s_mov_b64 exec, -1
    v_add_u32_dpp v22, v22, v22 row_shr:1 row_mask:0xf bank_mask:0xf bound_ctrl:0
    v_add_u32_dpp v23, v23, v23 row_shr:1 row_mask:0xf bank_mask:0xf bound_ctrl:0
    v_add_u32_dpp v24, v24, v24 row_shr:1 row_mask:0xf bank_mask:0xf bound_ctrl:0
    v_add_u32_dpp v25, v25, v25 row_shr:1 row_mask:0xf bank_mask:0xf bound_ctrl:0
    v_add_u32_dpp v22, v22, v22 row_shr:2 row_mask:0xf bank_mask:0xf bound_ctrl:0
    v_add_u32_dpp v23, v23, v23 row_shr:2 row_mask:0xf bank_mask:0xf bound_ctrl:0
    v_add_u32_dpp v24, v24, v24 row_shr:2 row_mask:0xf bank_mask:0xf bound_ctrl:0
    v_add_u32_dpp v25, v25, v25 row_shr:2 row_mask:0xf bank_mask:0xf bound_ctrl:0
    v_add_u32_dpp v22, v22, v22 row_shr:4 row_mask:0xf bank_mask:0xf bound_ctrl:0
    v_add_u32_dpp v23, v23, v23 row_shr:4 row_mask:0xf bank_mask:0xf bound_ctrl:0
    v_add_u32_dpp v24, v24, v24 row_shr:4 row_mask:0xf bank_mask:0xf bound_ctrl:0
    v_add_u32_dpp v25, v25, v25 row_shr:4 row_mask:0xf bank_mask:0xf bound_ctrl:0
    v_add_u32_dpp v22, v22, v22 row_shr:8 row_mask:0xf bank_mask:0xf bound_ctrl:0
    v_add_u32_dpp v23, v23, v23 row_shr:8 row_mask:0xf bank_mask:0xf bound_ctrl:0
    v_add_u32_dpp v24, v24, v24 row_shr:8 row_mask:0xf bank_mask:0xf bound_ctrl:0
    v_add_u32_dpp v25, v25, v25 row_shr:8 row_mask:0xf bank_mask:0xf bound_ctrl:0
    v_add_u32_dpp v22, v22, v22 row_bcast:15 row_mask:0xa bank_mask:0xf
    v_add_u32_dpp v23, v23, v23 row_bcast:15 row_mask:0xa bank_mask:0xf
    v_add_u32_dpp v24, v24, v24 row_bcast:15 row_mask:0xa bank_mask:0xf
    v_add_u32_dpp v25, v25, v25 row_bcast:15 row_mask:0xa bank_mask:0xf
    v_add_u32_dpp v22, v22, v22 row_bcast:31 row_mask:0xc bank_mask:0xf
    v_add_u32_dpp v23, v23, v23 row_bcast:31 row_mask:0xc bank_mask:0xf
    v_add_u32_dpp v24, v24, v24 row_bcast:31 row_mask:0xc bank_mask:0xf
    v_add_u32_dpp v25, v25, v25 row_bcast:31 row_mask:0xc bank_mask:0xf
    v_readlane_b32 s56, v22, 63
    v_readlane_b32 s57, v23, 63
    v_readlane_b32 s58, v24, 63
    v_readlane_b32 s59, v25, 63
    v_add_u32 v22, s5, v22
    s_add_u32 s5, s5, s56
    v_add_u32 v23, s5, v23
    s_add_u32 s5, s5, s57
    v_add_u32 v24, s5, v24
    s_add_u32 s5, s5, s58
    v_add_u32 v25, s5, v25
    s_add_u32 s5, s5, s59
    s_waitcnt vmcnt(2) lgkmcnt(2)
    s_mov_b64 exec, s[46:47]
    v_pk_mul_f32 v[116:117], v[100:101], v[104:105] op_sel_hi:[1,0]
    v_fma_mix_f32 v118, v100, v104, 0 op_sel_hi:[1,0,0]
    v_fma_mix_f32 v119, v101, v104, 0 op_sel_hi:[1,0,0]
    v_dot2c_f32_bf16 v116, v97, v103
    v_dot2c_f32_bf16 v117, v99, v103
    v_dot2c_f32_bf16 v118, v96, v103
    v_dot2c_f32_bf16 v119, v98, v103
    v_lshlrev_b32 v120, 16, v78
    v_lshlrev_b32 v121, 16, v79
    v_pk_fma_f32 v[88:89], v[78:79], v[116:117], v[6:7] op_sel_hi:[1,1,0]
    v_pk_fma_f32 v[90:91], v[120:121], v[118:119], v[6:7] op_sel_hi:[1,1,0]
    v_lshl_add_u64 v[88:89], v[88:89], 0, v[4:5]
    v_lshl_add_u64 v[90:91], v[90:91], 0, v[4:5]
    ds_add_rtn_u64 v[88:89], v102, v[88:89] offset:34048
    ds_add_rtn_u64 v[90:91], v102, v[90:91] offset:44288
    s_mov_b64 exec, -1
    ds_read_b32 v76, v12 offset:29120
    v_readlane_b32 s33, v8, 6
    v_and_b32 v84, 0x1ff, v75
    s_add_u32 s4, s32, 344064
    s_bfm_b64 exec, s33, 0
    s_bitcmp1_b32 s33, 6
    s_cselect_b64 exec, -1, exec
    s_mov_b64 s[52:53], exec
    buffer_load_dwordx2 v[84:85], v84, s[12:15], s4 idxen
    s_mov_b64 exec, s[50:51]
    v_lshrrev_b32 v102, 6, v74
    v_cvt_f32_i32 v103, v74
    v_and_b32 v102, 0x3ff8, v102
    v_add_u32 v105, v102, v102
    ds_read_b64 v[100:101], v102 offset:23808
    ds_read_b128 v[96:99], v105 offset:3328
    v_fmaak_f32 v105, v103, v103, 0xddffc004
    v_fmaak_f32 v104, v105, v7, 0xb0001002
    v_mul_f32 v104, v104, v103
    v_cvt_pk_bf16_f32 v103, v103, v105
    s_mov_b64 exec, -1
    s_sub_u32 s26, s17, 0
    v_lshlrev_b32_sdwa v46, 2, v45 dst_sel:DWORD dst_unused:UNUSED_PAD src0_sel:DWORD src1_sel:BYTE_0
    v_lshlrev_b32_sdwa v47, 2, v45 dst_sel:DWORD dst_unused:UNUSED_PAD src0_sel:DWORD src1_sel:BYTE_1
    v_lshlrev_b32_sdwa v48, 2, v45 dst_sel:DWORD dst_unused:UNUSED_PAD src0_sel:DWORD src1_sel:BYTE_2
    v_lshlrev_b32_sdwa v49, 2, v45 dst_sel:DWORD dst_unused:UNUSED_PAD src0_sel:DWORD src1_sel:BYTE_3
    v_cmpx_gt_i32_e64 s[42:43], s26, v1
    ds_add_rtn_u32 v46, v46, v11 offset:768
    ds_add_rtn_u32 v47, v47, v11 offset:768
    ds_add_rtn_u32 v48, v48, v11 offset:768
    ds_add_rtn_u32 v49, v49, v11 offset:768
    s_mov_b64 exec, -1
    s_waitcnt vmcnt(2) lgkmcnt(9)
    s_mov_b64 exec, s[48:49]
    v_pk_mul_f32 v[116:117], v[110:111], v[114:115] op_sel_hi:[1,0]
    v_fma_mix_f32 v118, v110, v114, 0 op_sel_hi:[1,0,0]
    v_fma_mix_f32 v119, v111, v114, 0 op_sel_hi:[1,0,0]
    v_dot2c_f32_bf16 v116, v107, v113
    v_dot2c_f32_bf16 v117, v109, v113
    v_dot2c_f32_bf16 v118, v106, v113
    v_dot2c_f32_bf16 v119, v108, v113
    v_lshlrev_b32 v120, 16, v80
    v_lshlrev_b32 v121, 16, v81
    v_pk_fma_f32 v[92:93], v[80:81], v[116:117], v[6:7] op_sel_hi:[1,1,0]
    v_pk_fma_f32 v[94:95], v[120:121], v[118:119], v[6:7] op_sel_hi:[1,1,0]
    v_lshl_add_u64 v[92:93], v[92:93], 0, v[4:5]
    v_lshl_add_u64 v[94:95], v[94:95], 0, v[4:5]
    ds_add_rtn_u64 v[92:93], v112, v[92:93] offset:34048
    ds_add_rtn_u64 v[94:95], v112, v[94:95] offset:44288
    s_mov_b64 exec, -1
    ds_read_b32 v77, v12 offset:33280
    s_waitcnt lgkmcnt(9)
    v_readlane_b32 s33, v8, 7
    v_and_b32 v86, 0x1ff, v76
    s_add_u32 s4, s32, 401408
    s_bfm_b64 exec, s33, 0
    s_bitcmp1_b32 s33, 6
    s_cselect_b64 exec, -1, exec
    s_mov_b64 s[54:55], exec
    buffer_load_dwordx2 v[86:87], v86, s[12:15], s4 idxen
    s_mov_b64 exec, -1
    s_waitcnt lgkmcnt(3)
    v_lshlrev_b32_sdwa v122, 2, v46 dst_sel:DWORD dst_unused:UNUSED_PAD src0_sel:DWORD src1_sel:WORD_0
    v_lshlrev_b32_sdwa v123, 2, v47 dst_sel:DWORD dst_unused:UNUSED_PAD src0_sel:DWORD src1_sel:WORD_0
    v_lshlrev_b32_sdwa v124, 2, v48 dst_sel:DWORD dst_unused:UNUSED_PAD src0_sel:DWORD src1_sel:WORD_0
    v_lshlrev_b32_sdwa v125, 2, v49 dst_sel:DWORD dst_unused:UNUSED_PAD src0_sel:DWORD src1_sel:WORD_0
    s_mov_b64 exec, s[42:43]
    v_cmpx_gt_i32_e64 s[80:81], s25, v46
    ds_write_b32 v122, v40
    s_mov_b64 exec, s[42:43]
    v_cmpx_gt_i32_e64 s[82:83], s25, v47
    ds_write_b32 v123, v41
    s_mov_b64 exec, s[42:43]
    v_cmpx_gt_i32_e64 s[84:85], s25, v48
    ds_write_b32 v124, v42
    s_mov_b64 exec, s[42:43]
    v_cmpx_gt_i32_e64 s[86:87], s25, v49
    ds_write_b32 v125, v44
    s_and_b64 s[88:89], s[80:81], s[82:83]
    s_and_b64 exec, exec, s[84:85]
    s_and_b64 s[88:89], s[88:89], exec
    s_cmp_eq_u64 s[88:89], s[42:43]
    s_cbranch_scc1 Lc_no_6
    s_mov_b64 exec, s[42:43]
    s_movk_i32 s90, 191
    s_call_b64 s[88:89], Lc_ovf40
Lc_no_6:
    s_mov_b64 exec, -1
    buffer_load_dwordx3 v[40:42], v20, s[20:23], 0 offen
    buffer_load_dwordx2 v[44:45], v20, s[20:23], 0 offen offset:12
    s_setprio 2
    s_mov_b64 exec, s[52:53]
    v_lshrrev_b32 v112, 6, v75
    v_cvt_f32_i32 v113, v75
    v_and_b32 v112, 0x3ff8, v112
    v_add_u32 v115, v112, v112
    ds_read_b64 v[110:111], v112 offset:23808
    ds_read_b128 v[106:109], v115 offset:3328
    v_fmaak_f32 v115, v113, v113, 0xddffc004
    v_fmaak_f32 v114, v115, v7, 0xb0001002
    v_mul_f32 v114, v114, v113
    v_cvt_pk_bf16_f32 v113, v113, v115
    s_waitcnt vmcnt(4)
    s_mov_b64 exec, s[50:51]
    v_bitop3_b32 v3, v3, v88, v89 bitop3:0xfe
    v_bitop3_b32 v3, v3, v90, v91 bitop3:0xfe
    v_pk_mul_f32 v[116:117], v[100:101], v[104:105] op_sel_hi:[1,0]
    v_fma_mix_f32 v118, v100, v104, 0 op_sel_hi:[1,0,0]
    v_fma_mix_f32 v119, v101, v104, 0 op_sel_hi:[1,0,0]
    v_dot2c_f32_bf16 v116, v97, v103
    v_dot2c_f32_bf16 v117, v99, v103
    v_dot2c_f32_bf16 v118, v96, v103
    v_dot2c_f32_bf16 v119, v98, v103
    v_lshlrev_b32 v120, 16, v82
    v_lshlrev_b32 v121, 16, v83
    v_pk_fma_f32 v[88:89], v[82:83], v[116:117], v[6:7] op_sel_hi:[1,1,0]
    v_pk_fma_f32 v[90:91], v[120:121], v[118:119], v[6:7] op_sel_hi:[1,1,0]
    v_lshl_add_u64 v[88:89], v[88:89], 0, v[4:5]
    v_lshl_add_u64 v[90:91], v[90:91], 0, v[4:5]
    ds_add_rtn_u64 v[88:89], v102, v[88:89] offset:34048
    ds_add_rtn_u64 v[90:91], v102, v[90:91] offset:44288
    s_mov_b64 exec, -1
    ds_read_b32 v72, v12 offset:37440
    s_waitcnt lgkmcnt(9)
    v_readlane_b32 s33, v8, 8
    v_and_b32 v78, 0x1ff, v77
    s_add_u32 s4, s32, 458752
    s_bfm_b64 exec, s33, 0
    s_bitcmp1_b32 s33, 6
    s_cselect_b64 exec, -1, exec
    s_mov_b64 s[46:47], exec
    buffer_load_dwordx2 v[78:79], v78, s[12:15], s4 idxen
    s_mov_b64 exec, -1
    s_sub_u32 s26, s17, 64
    v_lshlrev_b32_sdwa v56, 2, v55 dst_sel:DWORD dst_unused:UNUSED_PAD src0_sel:DWORD src1_sel:BYTE_0
    v_lshlrev_b32_sdwa v57, 2, v55 dst_sel:DWORD dst_unused:UNUSED_PAD src0_sel:DWORD src1_sel:BYTE_1
    v_lshlrev_b32_sdwa v58, 2, v55 dst_sel:DWORD dst_unused:UNUSED_PAD src0_sel:DWORD src1_sel:BYTE_2
    v_lshlrev_b32_sdwa v59, 2, v55 dst_sel:DWORD dst_unused:UNUSED_PAD src0_sel:DWORD src1_sel:BYTE_3
    v_cmpx_gt_i32_e64 s[44:45], s26, v1
    ds_add_rtn_u32 v56, v56, v11 offset:768
    ds_add_rtn_u32 v57, v57, v11 offset:768
    ds_add_rtn_u32 v58, v58, v11 offset:768
    ds_add_rtn_u32 v59, v59, v11 offset:768
    s_mov_b64 exec, s[54:55]
    v_lshrrev_b32 v102, 6, v76
    v_cvt_f32_i32 v103, v76
    v_and_b32 v102, 0x3ff8, v102
    v_add_u32 v105, v102, v102
    ds_read_b64 v[100:101], v102 offset:23808
    ds_read_b128 v[96:99], v105 offset:3328
    v_fmaak_f32 v105, v103, v103, 0xddffc004
    v_fmaak_f32 v104, v105, v7, 0xb0001002
    v_mul_f32 v104, v104, v103
    v_cvt_pk_bf16_f32 v103, v103, v105
    s_mov_b64 exec, -1
    s_waitcnt lgkmcnt(2)
    v_lshlrev_b32_sdwa v122, 2, v56 dst_sel:DWORD dst_unused:UNUSED_PAD src0_sel:DWORD src1_sel:WORD_0
    v_lshlrev_b32_sdwa v123, 2, v57 dst_sel:DWORD dst_unused:UNUSED_PAD src0_sel:DWORD src1_sel:WORD_0
    v_lshlrev_b32_sdwa v124, 2, v58 dst_sel:DWORD dst_unused:UNUSED_PAD src0_sel:DWORD src1_sel:WORD_0
    v_lshlrev_b32_sdwa v125, 2, v59 dst_sel:DWORD dst_unused:UNUSED_PAD src0_sel:DWORD src1_sel:WORD_0
    s_mov_b64 exec, s[44:45]
    v_cmpx_gt_i32_e64 s[80:81], s25, v56
    ds_write_b32 v122, v50
    s_mov_b64 exec, s[44:45]
    v_cmpx_gt_i32_e64 s[82:83], s25, v57
    ds_write_b32 v123, v51
    s_mov_b64 exec, s[44:45]
    v_cmpx_gt_i32_e64 s[84:85], s25, v58
    ds_write_b32 v124, v52
    s_mov_b64 exec, s[44:45]
    v_cmpx_gt_i32_e64 s[86:87], s25, v59
    ds_write_b32 v125, v54
    s_and_b64 s[88:89], s[80:81], s[82:83]
    s_and_b64 exec, exec, s[84:85]
    s_and_b64 s[88:89], s[88:89], exec
    s_cmp_eq_u64 s[88:89], s[44:45]
    s_cbranch_scc1 Lc_no_7
    s_mov_b64 exec, s[44:45]
    s_movk_i32 s90, 191
    s_call_b64 s[88:89], Lc_ovf50
Lc_no_7:
    s_mov_b64 exec, -1
    buffer_load_dwordx3 v[50:52], v21, s[20:23], 0 offen
    buffer_load_dwordx2 v[54:55], v21, s[20:23], 0 offen offset:12
    s_waitcnt vmcnt(6)
    s_mov_b64 exec, s[52:53]
    v_bitop3_b32 v3, v3, v92, v93 bitop3:0xfe
    v_bitop3_b32 v3, v3, v94, v95 bitop3:0xfe
    v_pk_mul_f32 v[116:117], v[110:111], v[114:115] op_sel_hi:[1,0]
    v_fma_mix_f32 v118, v110, v114, 0 op_sel_hi:[1,0,0]
    v_fma_mix_f32 v119, v111, v114, 0 op_sel_hi:[1,0,0]
    v_dot2c_f32_bf16 v116, v107, v113
    v_dot2c_f32_bf16 v117, v109, v113
    v_dot2c_f32_bf16 v118, v106, v113
    v_dot2c_f32_bf16 v119, v108, v113
    v_lshlrev_b32 v120, 16, v84
    v_lshlrev_b32 v121, 16, v85
    v_pk_fma_f32 v[92:93], v[84:85], v[116:117], v[6:7] op_sel_hi:[1,1,0]
    v_pk_fma_f32 v[94:95], v[120:121], v[118:119], v[6:7] op_sel_hi:[1,1,0]
    v_lshl_add_u64 v[92:93], v[92:93], 0, v[4:5]
    v_lshl_add_u64 v[94:95], v[94:95], 0, v[4:5]
    ds_add_rtn_u64 v[92:93], v112, v[92:93] offset:34048
    ds_add_rtn_u64 v[94:95], v112, v[94:95] offset:44288
    s_mov_b64 exec, -1
    ds_read_b32 v73, v12 offset:41600
    v_readlane_b32 s33, v8, 9
    v_and_b32 v80, 0x1ff, v72
    s_add_u32 s4, s32, 516096
    s_bfm_b64 exec, s33, 0
    s_bitcmp1_b32 s33, 6
    s_cselect_b64 exec, -1, exec
    s_mov_b64 s[48:49], exec
    buffer_load_dwordx2 v[80:81], v80, s[12:15], s4 idxen
    s_mov_b64 exec, -1
    s_setprio 1
    s_mov_b64 exec, s[46:47]
    v_lshrrev_b32 v112, 6, v77
    v_cvt_f32_i32 v113, v77
    v_and_b32 v112, 0x3ff8, v112
    v_add_u32 v115, v112, v112
    ds_read_b64 v[110:111], v112 offset:23808
    ds_read_b128 v[106:109], v115 offset:3328
    v_fmaak_f32 v115, v113, v113, 0xddffc004
    v_fmaak_f32 v114, v115, v7, 0xb0001002
    v_mul_f32 v114, v114, v113
    v_cvt_pk_bf16_f32 v113, v113, v115
    s_mov_b64 exec, -1
    s_sub_u32 s26, s17, 128
    s_waitcnt vmcnt(4)
    v_lshlrev_b32_sdwa v46, 2, v45 dst_sel:DWORD dst_unused:UNUSED_PAD src0_sel:DWORD src1_sel:BYTE_0
    v_lshlrev_b32_sdwa v47, 2, v45 dst_sel:DWORD dst_unused:UNUSED_PAD src0_sel:DWORD src1_sel:BYTE_1
    v_lshlrev_b32_sdwa v48, 2, v45 dst_sel:DWORD dst_unused:UNUSED_PAD src0_sel:DWORD src1_sel:BYTE_2
    v_lshlrev_b32_sdwa v49, 2, v45 dst_sel:DWORD dst_unused:UNUSED_PAD src0_sel:DWORD src1_sel:BYTE_3
    v_cmpx_gt_i32_e64 s[36:37], s26, v1
    ds_add_rtn_u32 v46, v46, v11 offset:768
    ds_add_rtn_u32 v47, v47, v11 offset:768
    ds_add_rtn_u32 v48, v48, v11 offset:768
    ds_add_rtn_u32 v49, v49, v11 offset:768
    s_mov_b64 exec, -1
    s_waitcnt lgkmcnt(13)
    s_mov_b64 exec, s[54:55]
    v_bitop3_b32 v3, v3, v88, v89 bitop3:0xfe
    v_bitop3_b32 v3, v3, v90, v91 bitop3:0xfe
    v_pk_mul_f32 v[116:117], v[100:101], v[104:105] op_sel_hi:[1,0]
    v_fma_mix_f32 v118, v100, v104, 0 op_sel_hi:[1,0,0]
    v_fma_mix_f32 v119, v101, v104, 0 op_sel_hi:[1,0,0]
    v_dot2c_f32_bf16 v116, v97, v103
    v_dot2c_f32_bf16 v117, v99, v103
    v_dot2c_f32_bf16 v118, v96, v103
    v_dot2c_f32_bf16 v119, v98, v103
    v_lshlrev_b32 v120, 16, v86
    v_lshlrev_b32 v121, 16, v87
    v_pk_fma_f32 v[88:89], v[86:87], v[116:117], v[6:7] op_sel_hi:[1,1,0]
    v_pk_fma_f32 v[90:91], v[120:121], v[118:119], v[6:7] op_sel_hi:[1,1,0]
    v_lshl_add_u64 v[88:89], v[88:89], 0, v[4:5]
    v_lshl_add_u64 v[90:91], v[90:91], 0, v[4:5]
    ds_add_rtn_u64 v[88:89], v102, v[88:89] offset:34048
    ds_add_rtn_u64 v[90:91], v102, v[90:91] offset:44288
    s_mov_b64 exec, -1
    ds_read_b32 v74, v12 offset:45760
    s_waitcnt lgkmcnt(9)
    v_readlane_b32 s33, v8, 10
    v_and_b32 v82, 0x1ff, v73
    s_add_u32 s4, s32, 573440
    s_bfm_b64 exec, s33, 0
    s_bitcmp1_b32 s33, 6
    s_cselect_b64 exec, -1, exec
    s_mov_b64 s[50:51], exec
    buffer_load_dwordx2 v[82:83], v82, s[12:15], s4 idxen
    s_mov_b64 exec, -1
    s_waitcnt lgkmcnt(3)
    v_lshlrev_b32_sdwa v122, 2, v46 dst_sel:DWORD dst_unused:UNUSED_PAD src0_sel:DWORD src1_sel:WORD_0
    v_lshlrev_b32_sdwa v123, 2, v47 dst_sel:DWORD dst_unused:UNUSED_PAD src0_sel:DWORD src1_sel:WORD_0
    v_lshlrev_b32_sdwa v124, 2, v48 dst_sel:DWORD dst_unused:UNUSED_PAD src0_sel:DWORD src1_sel:WORD_0
    v_lshlrev_b32_sdwa v125, 2, v49 dst_sel:DWORD dst_unused:UNUSED_PAD src0_sel:DWORD src1_sel:WORD_0
    s_mov_b64 exec, s[36:37]
    v_cmpx_gt_i32_e64 s[80:81], s25, v46
    ds_write_b32 v122, v40
    s_mov_b64 exec, s[36:37]
    v_cmpx_gt_i32_e64 s[82:83], s25, v47
    ds_write_b32 v123, v41
    s_mov_b64 exec, s[36:37]
    v_cmpx_gt_i32_e64 s[84:85], s25, v48
    ds_write_b32 v124, v42
    s_mov_b64 exec, s[36:37]
    v_cmpx_gt_i32_e64 s[86:87], s25, v49
    ds_write_b32 v125, v44
    s_and_b64 s[88:89], s[80:81], s[82:83]
    s_and_b64 exec, exec, s[84:85]
    s_and_b64 s[88:89], s[88:89], exec
    s_cmp_eq_u64 s[88:89], s[36:37]
    s_cbranch_scc1 Lc_no_8
    s_mov_b64 exec, s[36:37]
    s_movk_i32 s90, 191
    s_call_b64 s[88:89], Lc_ovf40
Lc_no_8:
    s_mov_b64 exec, -1
    buffer_load_dwordx3 v[40:42], v22, s[20:23], 0 offen
    buffer_load_dwordx2 v[44:45], v22, s[20:23], 0 offen offset:12
    s_mov_b64 exec, s[48:49]
    v_lshrrev_b32 v102, 6, v72
    v_cvt_f32_i32 v103, v72
    v_and_b32 v102, 0x3ff8, v102
    v_add_u32 v105, v102, v102
    ds_read_b64 v[100:101], v102 offset:23808
    ds_read_b128 v[96:99], v105 offset:3328
    v_fmaak_f32 v105, v103, v103, 0xddffc004
    v_fmaak_f32 v104, v105, v7, 0xb0001002
    v_mul_f32 v104, v104, v103
    v_cvt_pk_bf16_f32 v103, v103, v105
    s_waitcnt vmcnt(6)
    s_mov_b64 exec, s[46:47]
    v_bitop3_b32 v3, v3, v92, v93 bitop3:0xfe
    v_bitop3_b32 v3, v3, v94, v95 bitop3:0xfe
    v_pk_mul_f32 v[116:117], v[110:111], v[114:115] op_sel_hi:[1,0]
    v_fma_mix_f32 v118, v110, v114, 0 op_sel_hi:[1,0,0]
    v_fma_mix_f32 v119, v111, v114, 0 op_sel_hi:[1,0,0]
    v_dot2c_f32_bf16 v116, v107, v113
    v_dot2c_f32_bf16 v117, v109, v113
    v_dot2c_f32_bf16 v118, v106, v113
    v_dot2c_f32_bf16 v119, v108, v113
    v_lshlrev_b32 v120, 16, v78
    v_lshlrev_b32 v121, 16, v79
    v_pk_fma_f32 v[92:93], v[78:79], v[116:117], v[6:7] op_sel_hi:[1,1,0]
    v_pk_fma_f32 v[94:95], v[120:121], v[118:119], v[6:7] op_sel_hi:[1,1,0]
    v_lshl_add_u64 v[92:93], v[92:93], 0, v[4:5]
    v_lshl_add_u64 v[94:95], v[94:95], 0, v[4:5]
    ds_add_rtn_u64 v[92:93], v112, v[92:93] offset:34048
    ds_add_rtn_u64 v[94:95], v112, v[94:95] offset:44288
    s_mov_b64 exec, -1
    s_waitcnt lgkmcnt(8)
    v_readlane_b32 s33, v8, 11
    v_and_b32 v84, 0x1ff, v74
    s_add_u32 s4, s32, 630784
    s_bfm_b64 exec, s33, 0
    s_bitcmp1_b32 s33, 6
    s_cselect_b64 exec, -1, exec
    s_mov_b64 s[52:53], exec
    buffer_load_dwordx2 v[84:85], v84, s[12:15], s4 idxen
    s_mov_b64 exec, -1
    s_sub_u32 s26, s17, 192
    s_cmp_le_i32 s26, 0
    s_cbranch_scc1 Lc_rare_9
    s_waitcnt vmcnt(5)
    v_lshlrev_b32_sdwa v56, 2, v55 dst_sel:DWORD dst_unused:UNUSED_PAD src0_sel:DWORD src1_sel:BYTE_0
    v_lshlrev_b32_sdwa v57, 2, v55 dst_sel:DWORD dst_unused:UNUSED_PAD src0_sel:DWORD src1_sel:BYTE_1
    v_lshlrev_b32_sdwa v58, 2, v55 dst_sel:DWORD dst_unused:UNUSED_PAD src0_sel:DWORD src1_sel:BYTE_2
    v_lshlrev_b32_sdwa v59, 2, v55 dst_sel:DWORD dst_unused:UNUSED_PAD src0_sel:DWORD src1_sel:BYTE_3
    v_cmpx_gt_i32_e64 s[38:39], s26, v1
    ds_add_rtn_u32 v56, v56, v11 offset:768
    ds_add_rtn_u32 v57, v57, v11 offset:768
    ds_add_rtn_u32 v58, v58, v11 offset:768
    ds_add_rtn_u32 v59, v59, v11 offset:768
    s_mov_b64 exec, -1
Lc_rare_9:
    s_setprio 0
    s_mov_b64 exec, s[50:51]
    v_lshrrev_b32 v112, 6, v73
    v_cvt_f32_i32 v113, v73
    v_and_b32 v112, 0x3ff8, v112
    v_add_u32 v115, v112, v112
    ds_read_b64 v[110:111], v112 offset:23808
    ds_read_b128 v[106:109], v115 offset:3328
    v_fmaak_f32 v115, v113, v113, 0xddffc004
    v_fmaak_f32 v114, v115, v7, 0xb0001002
    v_mul_f32 v114, v114, v113
    v_cvt_pk_bf16_f32 v113, v113, v115
    s_mov_b64 exec, -1
    s_cmp_le_u32 s17, 192
    s_cbranch_scc1 Lc_rare_10
    s_waitcnt lgkmcnt(2)
    v_lshlrev_b32_sdwa v122, 2, v56 dst_sel:DWORD dst_unused:UNUSED_PAD src0_sel:DWORD src1_sel:WORD_0
    v_lshlrev_b32_sdwa v123, 2, v57 dst_sel:DWORD dst_unused:UNUSED_PAD src0_sel:DWORD src1_sel:WORD_0
    v_lshlrev_b32_sdwa v124, 2, v58 dst_sel:DWORD dst_unused:UNUSED_PAD src0_sel:DWORD src1_sel:WORD_0
    v_lshlrev_b32_sdwa v125, 2, v59 dst_sel:DWORD dst_unused:UNUSED_PAD src0_sel:DWORD src1_sel:WORD_0
    s_mov_b64 exec, s[38:39]
    v_cmpx_gt_i32_e64 s[80:81], s25, v56
    ds_write_b32 v122, v50
    s_mov_b64 exec, s[38:39]
    v_cmpx_gt_i32_e64 s[82:83], s25, v57
    ds_write_b32 v123, v51
    s_mov_b64 exec, s[38:39]
    v_cmpx_gt_i32_e64 s[84:85], s25, v58
    ds_write_b32 v124, v52
    s_mov_b64 exec, s[38:39]
    v_cmpx_gt_i32_e64 s[86:87], s25, v59
    ds_write_b32 v125, v54
    s_and_b64 s[88:89], s[80:81], s[82:83]
    s_and_b64 exec, exec, s[84:85]
    s_and_b64 s[88:89], s[88:89], exec
    s_cmp_eq_u64 s[88:89], s[38:39]
    s_cbranch_scc1 Lc_no_11
    s_mov_b64 exec, s[38:39]
    s_movk_i32 s90, 191
    s_call_b64 s[88:89], Lc_ovf50
Lc_no_11:
    s_mov_b64 exec, -1
Lc_rare_10:
    buffer_load_dwordx3 v[50:52], v23, s[20:23], 0 offen
    buffer_load_dwordx2 v[54:55], v23, s[20:23], 0 offen offset:12
    s_waitcnt vmcnt(6) lgkmcnt(4)
    s_mov_b64 exec, s[48:49]
    v_bitop3_b32 v3, v3, v88, v89 bitop3:0xfe
    v_bitop3_b32 v3, v3, v90, v91 bitop3:0xfe
    v_pk_mul_f32 v[116:117], v[100:101], v[104:105] op_sel_hi:[1,0]
    v_fma_mix_f32 v118, v100, v104, 0 op_sel_hi:[1,0,0]
    v_fma_mix_f32 v119, v101, v104, 0 op_sel_hi:[1,0,0]
    v_dot2c_f32_bf16 v116, v97, v103
    v_dot2c_f32_bf16 v117, v99, v103
    v_dot2c_f32_bf16 v118, v96, v103
    v_dot2c_f32_bf16 v119, v98, v103
    v_lshlrev_b32 v120, 16, v80
    v_lshlrev_b32 v121, 16, v81
    v_pk_fma_f32 v[88:89], v[80:81], v[116:117], v[6:7] op_sel_hi:[1,1,0]
    v_pk_fma_f32 v[90:91], v[120:121], v[118:119], v[6:7] op_sel_hi:[1,1,0]
    v_lshl_add_u64 v[88:89], v[88:89], 0, v[4:5]
    v_lshl_add_u64 v[90:91], v[90:91], 0, v[4:5]
    ds_add_rtn_u64 v[88:89], v102, v[88:89] offset:34048
    ds_add_rtn_u64 v[90:91], v102, v[90:91] offset:44288
    s_mov_b64 exec, -1
    s_waitcnt lgkmcnt(2)
    s_barrier
    s_setprio 3
    ds_read_b32 v8, v9 offset:768
    ds_read_b32 v75, v13 offset:0
    ds_read_b32 v76, v13 offset:4160
    s_waitcnt lgkmcnt(1)
    v_ashrrev_i32 v8, 16, v8
    v_med3_i32 v8, v8, 0, 64
    s_nop 0
    v_readlane_b32 s33, v8, 0
    v_and_b32 v86, 0x1ff, v75
    s_add_u32 s4, s32, 684544
    s_bfm_b64 exec, s33, 0
    s_bitcmp1_b32 s33, 6
    s_cselect_b64 exec, -1, exec
    s_mov_b64 s[54:55], exec
    buffer_load_dwordx2 v[86:87], v86, s[12:15], s4 idxen
    s_mov_b64 exec, s[52:53]
    v_lshrrev_b32 v102, 6, v74
    v_cvt_f32_i32 v103, v74
    v_and_b32 v102, 0x3ff8, v102
    v_add_u32 v105, v102, v102
    ds_read_b64 v[100:101], v102 offset:23808
    ds_read_b128 v[96:99], v105 offset:3328
    v_fmaak_f32 v105, v103, v103, 0xddffc004
    v_fmaak_f32 v104, v105, v7, 0xb0001002
    v_mul_f32 v104, v104, v103
    v_cvt_pk_bf16_f32 v103, v103, v105
    s_waitcnt vmcnt(6)
    s_mov_b64 exec, s[50:51]
    v_bitop3_b32 v3, v3, v92, v93 bitop3:0xfe
    v_bitop3_b32 v3, v3, v94, v95 bitop3:0xfe
    v_pk_mul_f32 v[116:117], v[110:111], v[114:115] op_sel_hi:[1,0]
    v_fma_mix_f32 v118, v110, v114, 0 op_sel_hi:[1,0,0]
    v_fma_mix_f32 v119, v111, v114, 0 op_sel_hi:[1,0,0]
    v_dot2c_f32_bf16 v116, v107, v113
    v_dot2c_f32_bf16 v117, v109, v113
    v_dot2c_f32_bf16 v118, v106, v113
    v_dot2c_f32_bf16 v119, v108, v113
    v_lshlrev_b32 v120, 16, v82
    v_lshlrev_b32 v121, 16, v83
    v_pk_fma_f32 v[92:93], v[82:83], v[116:117], v[6:7] op_sel_hi:[1,1,0]
    v_pk_fma_f32 v[94:95], v[120:121], v[118:119], v[6:7] op_sel_hi:[1,1,0]
    v_lshl_add_u64 v[92:93], v[92:93], 0, v[4:5]
    v_lshl_add_u64 v[94:95], v[94:95], 0, v[4:5]
    ds_add_rtn_u64 v[92:93], v112, v[92:93] offset:34048
    ds_add_rtn_u64 v[94:95], v112, v[94:95] offset:44288
    s_mov_b64 exec, -1
    ds_read_b32 v77, v13 offset:8320
    s_waitcnt lgkmcnt(5)
    v_readlane_b32 s33, v8, 1
    v_and_b32 v78, 0x1ff, v76
    s_add_u32 s4, s32, 741888
    s_bfm_b64 exec, s33, 0
    s_bitcmp1_b32 s33, 6
    s_cselect_b64 exec, -1, exec
    s_mov_b64 s[46:47], exec
    buffer_load_dwordx2 v[78:79], v78, s[12:15], s4 idxen
    s_mov_b64 exec, s[54:55]
    v_lshrrev_b32 v112, 6, v75
    v_cvt_f32_i32 v113, v75
    v_and_b32 v112, 0x3ff8, v112
    v_add_u32 v115, v112, v112
    ds_read_b64 v[110:111], v112 offset:23808
    ds_read_b128 v[106:109], v115 offset:3328
    v_fmaak_f32 v115, v113, v113, 0xddffc004
    v_fmaak_f32 v114, v115, v7, 0xb0001002
    v_mul_f32 v114, v114, v113
    v_cvt_pk_bf16_f32 v113, v113, v115
    s_mov_b64 exec, -1
    v_add_u32_dpp v26, v26, v26 row_shr:1 row_mask:0xf bank_mask:0xf bound_ctrl:0
    v_add_u32_dpp v27, v27, v27 row_shr:1 row_mask:0xf bank_mask:0xf bound_ctrl:0
    v_add_u32_dpp v28, v28, v28 row_shr:1 row_mask:0xf bank_mask:0xf bound_ctrl:0
    v_add_u32_dpp v29, v29, v29 row_shr:1 row_mask:0xf bank_mask:0xf bound_ctrl:0
    v_add_u32_dpp v26, v26, v26 row_shr:2 row_mask:0xf bank_mask:0xf bound_ctrl:0
    v_add_u32_dpp v27, v27, v27 row_shr:2 row_mask:0xf bank_mask:0xf bound_ctrl:0
    v_add_u32_dpp v28, v28, v28 row_shr:2 row_mask:0xf bank_mask:0xf bound_ctrl:0
    v_add_u32_dpp v29, v29, v29 row_shr:2 row_mask:0xf bank_mask:0xf bound_ctrl:0
    v_add_u32_dpp v26, v26, v26 row_shr:4 row_mask:0xf bank_mask:0xf bound_ctrl:0
    v_add_u32_dpp v27, v27, v27 row_shr:4 row_mask:0xf bank_mask:0xf bound_ctrl:0
    v_add_u32_dpp v28, v28, v28 row_shr:4 row_mask:0xf bank_mask:0xf bound_ctrl:0
    v_add_u32_dpp v29, v29, v29 row_shr:4 row_mask:0xf bank_mask:0xf bound_ctrl:0
    v_add_u32_dpp v26, v26, v26 row_shr:8 row_mask:0xf bank_mask:0xf bound_ctrl:0
    v_add_u32_dpp v27, v27, v27 row_shr:8 row_mask:0xf bank_mask:0xf bound_ctrl:0
    v_add_u32_dpp v28, v28, v28 row_shr:8 row_mask:0xf bank_mask:0xf bound_ctrl:0
    v_add_u32_dpp v29, v29, v29 row_shr:8 row_mask:0xf bank_mask:0xf bound_ctrl:0
    v_add_u32_dpp v26, v26, v26 row_bcast:15 row_mask:0xa bank_mask:0xf
    v_add_u32_dpp v27, v27, v27 row_bcast:15 row_mask:0xa bank_mask:0xf
    v_add_u32_dpp v28, v28, v28 row_bcast:15 row_mask:0xa bank_mask:0xf
    v_add_u32_dpp v29, v29, v29 row_bcast:15 row_mask:0xa bank_mask:0xf
    v_add_u32_dpp v26, v26, v26 row_bcast:31 row_mask:0xc bank_mask:0xf
    v_add_u32_dpp v27, v27, v27 row_bcast:31 row_mask:0xc bank_mask:0xf
    v_add_u32_dpp v28, v28, v28 row_bcast:31 row_mask:0xc bank_mask:0xf
    v_add_u32_dpp v29, v29, v29 row_bcast:31 row_mask:0xc bank_mask:0xf
    v_readlane_b32 s56, v26, 63
    v_readlane_b32 s57, v27, 63
    v_readlane_b32 s58, v28, 63
    v_readlane_b32 s59, v29, 63
    v_add_u32 v26, s5, v26
    s_add_u32 s5, s5, s56
    v_add_u32 v27, s5, v27
    s_add_u32 s5, s5, s57
    v_add_u32 v28, s5, v28
    s_add_u32 s5, s5, s58
    v_add_u32 v29, s5, v29
    s_add_u32 s5, s5, s59
    s_waitcnt vmcnt(4) lgkmcnt(5)
    s_mov_b64 exec, s[52:53]
    v_bitop3_b32 v3, v3, v88, v89 bitop3:0xfe
    v_bitop3_b32 v3, v3, v90, v91 bitop3:0xfe
    v_pk_mul_f32 v[116:117], v[100:101], v[104:105] op_sel_hi:[1,0]
    v_fma_mix_f32 v118, v100, v104, 0 op_sel_hi:[1,0,0]
    v_fma_mix_f32 v119, v101, v104, 0 op_sel_hi:[1,0,0]
    v_dot2c_f32_bf16 v116, v97, v103
    v_dot2c_f32_bf16 v117, v99, v103
    v_dot2c_f32_bf16 v118, v96, v103
    v_dot2c_f32_bf16 v119, v98, v103
    v_lshlrev_b32 v120, 16, v84
    v_lshlrev_b32 v121, 16, v85
    v_pk_fma_f32 v[88:89], v[84:85], v[116:117], v[6:7] op_sel_hi:[1,1,0]
    v_pk_fma_f32 v[90:91], v[120:121], v[118:119], v[6:7] op_sel_hi:[1,1,0]
    v_lshl_add_u64 v[88:89], v[88:89], 0, v[4:5]
    v_lshl_add_u64 v[90:91], v[90:91], 0, v[4:5]
    ds_add_rtn_u64 v[88:89], v102, v[88:89] offset:34048
    ds_add_rtn_u64 v[90:91], v102, v[90:91] offset:44288
    s_mov_b64 exec, -1
    ds_read_b32 v72, v13 offset:12480
    s_waitcnt lgkmcnt(5)
    v_readlane_b32 s33, v8, 2
    v_and_b32 v80, 0x1ff, v77
    s_add_u32 s4, s32, 799232
    s_bfm_b64 exec, s33, 0
    s_bitcmp1_b32 s33, 6
    s_cselect_b64 exec, -1, exec
    s_mov_b64 s[48:49], exec
    buffer_load_dwordx2 v[80:81], v80, s[12:15], s4 idxen
    s_mov_b64 exec, s[46:47]
    v_lshrrev_b32 v102, 6, v76
    v_cvt_f32_i32 v103, v76
    v_and_b32 v102, 0x3ff8, v102
    v_add_u32 v105, v102, v102
    ds_read_b64 v[100:101], v102 offset:23808
    ds_read_b128 v[96:99], v105 offset:3328
    v_fmaak_f32 v105, v103, v103, 0xddffc004
    v_fmaak_f32 v104, v105, v7, 0xb0001002
    v_mul_f32 v104, v104, v103
    v_cvt_pk_bf16_f32 v103, v103, v105
    s_mov_b64 exec, -1
    s_sub_u32 s26, s18, 0
    v_lshlrev_b32_sdwa v46, 2, v45 dst_sel:DWORD dst_unused:UNUSED_PAD src0_sel:DWORD src1_sel:BYTE_0
    v_lshlrev_b32_sdwa v47, 2, v45 dst_sel:DWORD dst_unused:UNUSED_PAD src0_sel:DWORD src1_sel:BYTE_1
    v_lshlrev_b32_sdwa v48, 2, v45 dst_sel:DWORD dst_unused:UNUSED_PAD src0_sel:DWORD src1_sel:BYTE_2
    v_lshlrev_b32_sdwa v49, 2, v45 dst_sel:DWORD dst_unused:UNUSED_PAD src0_sel:DWORD src1_sel:BYTE_3
    v_cmpx_gt_i32_e64 s[40:41], s26, v1
    ds_add_rtn_u32 v46, v46, v11 offset:1536
    ds_add_rtn_u32 v47, v47, v11 offset:1536
    ds_add_rtn_u32 v48, v48, v11 offset:1536
    ds_add_rtn_u32 v49, v49, v11 offset:1536
    s_mov_b64 exec, -1
    s_waitcnt vmcnt(2) lgkmcnt(9)
    s_mov_b64 exec, s[54:55]
    v_bitop3_b32 v3, v3, v92, v93 bitop3:0xfe
    v_bitop3_b32 v3, v3, v94, v95 bitop3:0xfe
    v_pk_mul_f32 v[116:117], v[110:111], v[114:115] op_sel_hi:[1,0]
    v_fma_mix_f32 v118, v110, v114, 0 op_sel_hi:[1,0,0]
    v_fma_mix_f32 v119, v111, v114, 0 op_sel_hi:[1,0,0]
    v_dot2c_f32_bf16 v116, v107, v113
    v_dot2c_f32_bf16 v117, v109, v113
    v_dot2c_f32_bf16 v118, v106, v113
    v_dot2c_f32_bf16 v119, v108, v113
    v_lshlrev_b32 v120, 16, v86
    v_lshlrev_b32 v121, 16, v87
    v_pk_fma_f32 v[92:93], v[86:87], v[116:117], v[6:7] op_sel_hi:[1,1,0]
    v_pk_fma_f32 v[94:95], v[120:121], v[118:119], v[6:7] op_sel_hi:[1,1,0]
    v_lshl_add_u64 v[92:93], v[92:93], 0, v[4:5]
    v_lshl_add_u64 v[94:95], v[94:95], 0, v[4:5]
    ds_add_rtn_u64 v[92:93], v112, v[92:93] offset:34048
    ds_add_rtn_u64 v[94:95], v112, v[94:95] offset:44288
    s_mov_b64 exec, -1
    ds_read_b32 v73, v13 offset:16640
    s_waitcnt lgkmcnt(9)
    v_readlane_b32 s33, v8, 3
    v_and_b32 v82, 0x1ff, v72
    s_add_u32 s4, s32, 856576
    s_bfm_b64 exec, s33, 0
    s_bitcmp1_b32 s33, 6
    s_cselect_b64 exec, -1, exec
    s_mov_b64 s[50:51], exec
    buffer_load_dwordx2 v[82:83], v82, s[12:15], s4 idxen
    s_mov_b64 exec, -1
    s_waitcnt lgkmcnt(3)
    v_lshlrev_b32_sdwa v122, 2, v46 dst_sel:DWORD dst_unused:UNUSED_PAD src0_sel:DWORD src1_sel:WORD_0
    v_lshlrev_b32_sdwa v123, 2, v47 dst_sel:DWORD dst_unused:UNUSED_PAD src0_sel:DWORD src1_sel:WORD_0
    v_lshlrev_b32_sdwa v124, 2, v48 dst_sel:DWORD dst_unused:UNUSED_PAD src0_sel:DWORD src1_sel:WORD_0
    v_lshlrev_b32_sdwa v125, 2, v49 dst_sel:DWORD dst_unused:UNUSED_PAD src0_sel:DWORD src1_sel:WORD_0
    s_mov_b64 exec, s[40:41]
    v_cmpx_gt_i32_e64 s[80:81], s25, v46
    ds_write_b32 v122, v40
    s_mov_b64 exec, s[40:41]
    v_cmpx_gt_i32_e64 s[82:83], s25, v47
    ds_write_b32 v123, v41
    s_mov_b64 exec, s[40:41]
    v_cmpx_gt_i32_e64 s[84:85], s25, v48
    ds_write_b32 v124, v42
    s_mov_b64 exec, s[40:41]
    v_cmpx_gt_i32_e64 s[86:87], s25, v49
    ds_write_b32 v125, v44
    s_and_b64 s[88:89], s[80:81], s[82:83]
    s_and_b64 exec, exec, s[84:85]
    s_and_b64 s[88:89], s[88:89], exec
    s_cmp_eq_u64 s[88:89], s[40:41]
    s_cbranch_scc1 Lc_no_12
    s_mov_b64 exec, s[40:41]
    s_movk_i32 s90, 382
    s_call_b64 s[88:89], Lc_ovf40
Lc_no_12:
    s_mov_b64 exec, -1
    buffer_load_dwordx3 v[40:42], v24, s[20:23], 0 offen
    buffer_load_dwordx2 v[44:45], v24, s[20:23], 0 offen offset:12
    s_mov_b64 exec, s[48:49]
    v_lshrrev_b32 v112, 6, v77
    v_cvt_f32_i32 v113, v77
    v_and_b32 v112, 0x3ff8, v112
    v_add_u32 v115, v112, v112
    ds_read_b64 v[110:111], v112 offset:23808
    ds_read_b128 v[106:109], v115 offset:3328
    v_fmaak_f32 v115, v113, v113, 0xddffc004
    v_fmaak_f32 v114, v115, v7, 0xb0001002
    v_mul_f32 v114, v114, v113
    v_cvt_pk_bf16_f32 v113, v113, v115
    s_waitcnt vmcnt(4)
    s_mov_b64 exec, s[46:47]
    v_bitop3_b32 v3, v3, v88, v89 bitop3:0xfe
    v_bitop3_b32 v3, v3, v90, v91 bitop3:0xfe
    v_pk_mul_f32 v[116:117], v[100:101], v[104:105] op_sel_hi:[1,0]
    v_fma_mix_f32 v118, v100, v104, 0 op_sel_hi:[1,0,0]
    v_fma_mix_f32 v119, v101, v104, 0 op_sel_hi:[1,0,0]
    v_dot2c_f32_bf16 v116, v97, v103
    v_dot2c_f32_bf16 v117, v99, v103
    v_dot2c_f32_bf16 v118, v96, v103
    v_dot2c_f32_bf16 v119, v98, v103
    v_lshlrev_b32 v120, 16, v78
    v_lshlrev_b32 v121, 16, v79
    v_pk_fma_f32 v[88:89], v[78:79], v[116:117], v[6:7] op_sel_hi:[1,1,0]
    v_pk_fma_f32 v[90:91], v[120:121], v[118:119], v[6:7] op_sel_hi:[1,1,0]
    v_lshl_add_u64 v[88:89], v[88:89], 0, v[4:5]
    v_lshl_add_u64 v[90:91], v[90:91], 0, v[4:5]
    ds_add_rtn_u64 v[88:89], v102, v[88:89] offset:34048
    ds_add_rtn_u64 v[90:91], v102, v[90:91] offset:44288
    s_mov_b64 exec, -1
    ds_read_b32 v74, v13 offset:20800
    s_waitcnt lgkmcnt(9)
    v_readlane_b32 s33, v8, 4
    v_and_b32 v84, 0x1ff, v73
    s_add_u32 s4, s32, 913920
    s_bfm_b64 exec, s33, 0
    s_bitcmp1_b32 s33, 6
    s_cselect_b64 exec, -1, exec
    s_mov_b64 s[52:53], exec
    buffer_load_dwordx2 v[84:85], v84, s[12:15], s4 idxen
    s_mov_b64 exec, -1
    s_setprio 2
    s_mov_b64 exec, s[50:51]
    v_lshrrev_b32 v102, 6, v72
    v_cvt_f32_i32 v103, v72
    v_and_b32 v102, 0x3ff8, v102
    v_add_u32 v105, v102, v102
    ds_read_b64 v[100:101], v102 offset:23808
    ds_read_b128 v[96:99], v105 offset:3328
    v_fmaak_f32 v105, v103, v103, 0xddffc004
    v_fmaak_f32 v104, v105, v7, 0xb0001002
    v_mul_f32 v104, v104, v103
    v_cvt_pk_bf16_f32 v103, v103, v105
    s_waitcnt vmcnt(4) lgkmcnt(5)
    s_mov_b64 exec, s[48:49]
    v_bitop3_b32 v3, v3, v92, v93 bitop3:0xfe
    v_bitop3_b32 v3, v3, v94, v95 bitop3:0xfe
    v_pk_mul_f32 v[116:117], v[110:111], v[114:115] op_sel_hi:[1,0]
    v_fma_mix_f32 v118, v110, v114, 0 op_sel_hi:[1,0,0]
    v_fma_mix_f32 v119, v111, v114, 0 op_sel_hi:[1,0,0]
    v_dot2c_f32_bf16 v116, v107, v113
    v_dot2c_f32_bf16 v117, v109, v113
    v_dot2c_f32_bf16 v118, v106, v113
    v_dot2c_f32_bf16 v119, v108, v113
    v_lshlrev_b32 v120, 16, v80
    v_lshlrev_b32 v121, 16, v81
    v_pk_fma_f32 v[92:93], v[80:81], v[116:117], v[6:7] op_sel_hi:[1,1,0]
    v_pk_fma_f32 v[94:95], v[120:121], v[118:119], v[6:7] op_sel_hi:[1,1,0]
    v_lshl_add_u64 v[92:93], v[92:93], 0, v[4:5]
    v_lshl_add_u64 v[94:95], v[94:95], 0, v[4:5]
    ds_add_rtn_u64 v[92:93], v112, v[92:93] offset:34048
    ds_add_rtn_u64 v[94:95], v112, v[94:95] offset:44288
    s_mov_b64 exec, -1
    ds_read_b32 v75, v13 offset:24960
    s_waitcnt lgkmcnt(5)
    v_readlane_b32 s33, v8, 5
    v_and_b32 v86, 0x1ff, v74
    s_add_u32 s4, s32, 971264
    s_bfm_b64 exec, s33, 0
    s_bitcmp1_b32 s33, 6
    s_cselect_b64 exec, -1, exec
    s_mov_b64 s[54:55], exec
    buffer_load_dwordx2 v[86:87], v86, s[12:15], s4 idxen
    s_mov_b64 exec, -1
    s_sub_u32 s26, s18, 64
    v_lshlrev_b32_sdwa v56, 2, v55 dst_sel:DWORD dst_unused:UNUSED_PAD src0_sel:DWORD src1_sel:BYTE_0
    v_lshlrev_b32_sdwa v57, 2, v55 dst_sel:DWORD dst_unused:UNUSED_PAD src0_sel:DWORD src1_sel:BYTE_1
    v_lshlrev_b32_sdwa v58, 2, v55 dst_sel:DWORD dst_unused:UNUSED_PAD src0_sel:DWORD src1_sel:BYTE_2
    v_lshlrev_b32_sdwa v59, 2, v55 dst_sel:DWORD dst_unused:UNUSED_PAD src0_sel:DWORD src1_sel:BYTE_3
    v_cmpx_gt_i32_e64 s[42:43], s26, v1
    ds_add_rtn_u32 v56, v56, v11 offset:1536
    ds_add_rtn_u32 v57, v57, v11 offset:1536
    ds_add_rtn_u32 v58, v58, v11 offset:1536
    ds_add_rtn_u32 v59, v59, v11 offset:1536
    s_mov_b64 exec, s[52:53]
    v_lshrrev_b32 v112, 6, v73
    v_cvt_f32_i32 v113, v73
    v_and_b32 v112, 0x3ff8, v112
    v_add_u32 v115, v112, v112
    ds_read_b64 v[110:111], v112 offset:23808
    ds_read_b128 v[106:109], v115 offset:3328
    v_fmaak_f32 v115, v113, v113, 0xddffc004
    v_fmaak_f32 v114, v115, v7, 0xb0001002
    v_mul_f32 v114, v114, v113
    v_cvt_pk_bf16_f32 v113, v113, v115
    s_mov_b64 exec, -1
    s_waitcnt lgkmcnt(2)
    v_lshlrev_b32_sdwa v122, 2, v56 dst_sel:DWORD dst_unused:UNUSED_PAD src0_sel:DWORD src1_sel:WORD_0
    v_lshlrev_b32_sdwa v123, 2, v57 dst_sel:DWORD dst_unused:UNUSED_PAD src0_sel:DWORD src1_sel:WORD_0
    v_lshlrev_b32_sdwa v124, 2, v58 dst_sel:DWORD dst_unused:UNUSED_PAD src0_sel:DWORD src1_sel:WORD_0
    v_lshlrev_b32_sdwa v125, 2, v59 dst_sel:DWORD dst_unused:UNUSED_PAD src0_sel:DWORD src1_sel:WORD_0
    s_mov_b64 exec, s[42:43]
    v_cmpx_gt_i32_e64 s[80:81], s25, v56
    ds_write_b32 v122, v50
    s_mov_b64 exec, s[42:43]
    v_cmpx_gt_i32_e64 s[82:83], s25, v57
    ds_write_b32 v123, v51
    s_mov_b64 exec, s[42:43]
    v_cmpx_gt_i32_e64 s[84:85], s25, v58
    ds_write_b32 v124, v52
    s_mov_b64 exec, s[42:43]
    v_cmpx_gt_i32_e64 s[86:87], s25, v59
    ds_write_b32 v125, v54
    s_and_b64 s[88:89], s[80:81], s[82:83]
    s_and_b64 exec, exec, s[84:85]
    s_and_b64 s[88:89], s[88:89], exec
    s_cmp_eq_u64 s[88:89], s[42:43]
    s_cbranch_scc1 Lc_no_13
    s_mov_b64 exec, s[42:43]
    s_movk_i32 s90, 382
    s_call_b64 s[88:89], Lc_ovf50
Lc_no_13:
    s_mov_b64 exec, -1
    buffer_load_dwordx3 v[50:52], v25, s[20:23], 0 offen
    buffer_load_dwordx2 v[54:55], v25, s[20:23], 0 offen offset:12
    s_waitcnt vmcnt(6)
    s_mov_b64 exec, s[50:51]
    v_bitop3_b32 v3, v3, v88, v89 bitop3:0xfe
    v_bitop3_b32 v3, v3, v90, v91 bitop3:0xfe
    v_pk_mul_f32 v[116:117], v[100:101], v[104:105] op_sel_hi:[1,0]
    v_fma_mix_f32 v118, v100, v104, 0 op_sel_hi:[1,0,0]
    v_fma_mix_f32 v119, v101, v104, 0 op_sel_hi:[1,0,0]
    v_dot2c_f32_bf16 v116, v97, v103
    v_dot2c_f32_bf16 v117, v99, v103
    v_dot2c_f32_bf16 v118, v96, v103
    v_dot2c_f32_bf16 v119, v98, v103
    v_lshlrev_b32 v120, 16, v82
    v_lshlrev_b32 v121, 16, v83
    v_pk_fma_f32 v[88:89], v[82:83], v[116:117], v[6:7] op_sel_hi:[1,1,0]
    v_pk_fma_f32 v[90:91], v[120:121], v[118:119], v[6:7] op_sel_hi:[1,1,0]
    v_lshl_add_u64 v[88:89], v[88:89], 0, v[4:5]
    v_lshl_add_u64 v[90:91], v[90:91], 0, v[4:5]
    ds_add_rtn_u64 v[88:89], v102, v[88:89] offset:34048
    ds_add_rtn_u64 v[90:91], v102, v[90:91] offset:44288
    s_mov_b64 exec, -1
    ds_read_b32 v76, v13 offset:29120
    v_readlane_b32 s33, v8, 6
    v_and_b32 v78, 0x1ff, v75
    s_add_u32 s4, s32, 1028608
    s_bfm_b64 exec, s33, 0
    s_bitcmp1_b32 s33, 6
    s_cselect_b64 exec, -1, exec
    s_mov_b64 s[46:47], exec
    buffer_load_dwordx2 v[78:79], v78, s[12:15], s4 idxen
    s_mov_b64 exec, s[54:55]
    v_lshrrev_b32 v102, 6, v74
    v_cvt_f32_i32 v103, v74
    v_and_b32 v102, 0x3ff8, v102
    v_add_u32 v105, v102, v102
    ds_read_b64 v[100:101], v102 offset:23808
    ds_read_b128 v[96:99], v105 offset:3328
    v_fmaak_f32 v105, v103, v103, 0xddffc004
    v_fmaak_f32 v104, v105, v7, 0xb0001002
    v_mul_f32 v104, v104, v103
    v_cvt_pk_bf16_f32 v103, v103, v105
    s_waitcnt vmcnt(4) lgkmcnt(9)
    s_mov_b64 exec, s[52:53]
    v_bitop3_b32 v3, v3, v92, v93 bitop3:0xfe
    v_bitop3_b32 v3, v3, v94, v95 bitop3:0xfe
    v_pk_mul_f32 v[116:117], v[110:111], v[114:115] op_sel_hi:[1,0]
    v_fma_mix_f32 v118, v110, v114, 0 op_sel_hi:[1,0,0]
    v_fma_mix_f32 v119, v111, v114, 0 op_sel_hi:[1,0,0]
    v_dot2c_f32_bf16 v116, v107, v113
    v_dot2c_f32_bf16 v117, v109, v113
    v_dot2c_f32_bf16 v118, v106, v113
    v_dot2c_f32_bf16 v119, v108, v113
    v_lshlrev_b32 v120, 16, v84
    v_lshlrev_b32 v121, 16, v85
    v_pk_fma_f32 v[92:93], v[84:85], v[116:117], v[6:7] op_sel_hi:[1,1,0]
    v_pk_fma_f32 v[94:95], v[120:121], v[118:119], v[6:7] op_sel_hi:[1,1,0]
    v_lshl_add_u64 v[92:93], v[92:93], 0, v[4:5]
    v_lshl_add_u64 v[94:95], v[94:95], 0, v[4:5]
    ds_add_rtn_u64 v[92:93], v112, v[92:93] offset:34048
    ds_add_rtn_u64 v[94:95], v112, v[94:95] offset:44288
    s_mov_b64 exec, -1
    ds_read_b32 v77, v13 offset:33280
    s_waitcnt lgkmcnt(5)
    v_readlane_b32 s33, v8, 7
    v_and_b32 v80, 0x1ff, v76
    s_add_u32 s4, s32, 1085952
    s_bfm_b64 exec, s33, 0
    s_bitcmp1_b32 s33, 6
    s_cselect_b64 exec, -1, exec
    s_mov_b64 s[48:49], exec
    buffer_load_dwordx2 v[80:81], v80, s[12:15], s4 idxen
    s_mov_b64 exec, -1
    s_setprio 1
    s_mov_b64 exec, s[46:47]
    v_lshrrev_b32 v112, 6, v75
    v_cvt_f32_i32 v113, v75
    v_and_b32 v112, 0x3ff8, v112
    v_add_u32 v115, v112, v112
    ds_read_b64 v[110:111], v112 offset:23808
    ds_read_b128 v[106:109], v115 offset:3328
    v_fmaak_f32 v115, v113, v113, 0xddffc004
    v_fmaak_f32 v114, v115, v7, 0xb0001002
    v_mul_f32 v114, v114, v113
    v_cvt_pk_bf16_f32 v113, v113, v115
    s_mov_b64 exec, -1
    s_sub_u32 s26, s18, 128
    v_lshlrev_b32_sdwa v46, 2, v45 dst_sel:DWORD dst_unused:UNUSED_PAD src0_sel:DWORD src1_sel:BYTE_0
    v_lshlrev_b32_sdwa v47, 2, v45 dst_sel:DWORD dst_unused:UNUSED_PAD src0_sel:DWORD src1_sel:BYTE_1
    v_lshlrev_b32_sdwa v48, 2, v45 dst_sel:DWORD dst_unused:UNUSED_PAD src0_sel:DWORD src1_sel:BYTE_2
    v_lshlrev_b32_sdwa v49, 2, v45 dst_sel:DWORD dst_unused:UNUSED_PAD src0_sel:DWORD src1_sel:BYTE_3
    v_cmpx_gt_i32_e64 s[44:45], s26, v1
    ds_add_rtn_u32 v46, v46, v11 offset:1536
    ds_add_rtn_u32 v47, v47, v11 offset:1536
    ds_add_rtn_u32 v48, v48, v11 offset:1536
    ds_add_rtn_u32 v49, v49, v11 offset:1536
    s_mov_b64 exec, -1
    s_waitcnt vmcnt(4) lgkmcnt(9)
    s_mov_b64 exec, s[54:55]
    v_bitop3_b32 v3, v3, v88, v89 bitop3:0xfe
    v_bitop3_b32 v3, v3, v90, v91 bitop3:0xfe
    v_pk_mul_f32 v[116:117], v[100:101], v[104:105] op_sel_hi:[1,0]
    v_fma_mix_f32 v118, v100, v104, 0 op_sel_hi:[1,0,0]
    v_fma_mix_f32 v119, v101, v104, 0 op_sel_hi:[1,0,0]
    v_dot2c_f32_bf16 v116, v97, v103
    v_dot2c_f32_bf16 v117, v99, v103
    v_dot2c_f32_bf16 v118, v96, v103
    v_dot2c_f32_bf16 v119, v98, v103
    v_lshlrev_b32 v120, 16, v86
    v_lshlrev_b32 v121, 16, v87
    v_pk_fma_f32 v[88:89], v[86:87], v[116:117], v[6:7] op_sel_hi:[1,1,0]
    v_pk_fma_f32 v[90:91], v[120:121], v[118:119], v[6:7] op_sel_hi:[1,1,0]
    v_lshl_add_u64 v[88:89], v[88:89], 0, v[4:5]
    v_lshl_add_u64 v[90:91], v[90:91], 0, v[4:5]
    ds_add_rtn_u64 v[88:89], v102, v[88:89] offset:34048
    ds_add_rtn_u64 v[90:91], v102, v[90:91] offset:44288
    s_mov_b64 exec, -1
    ds_read_b32 v72, v13 offset:37440
    s_waitcnt lgkmcnt(9)
    v_readlane_b32 s33, v8, 8
    v_and_b32 v82, 0x1ff, v77
    s_add_u32 s4, s32, 1143296
    s_bfm_b64 exec, s33, 0
    s_bitcmp1_b32 s33, 6
    s_cselect_b64 exec, -1, exec
    s_mov_b64 s[50:51], exec
    buffer_load_dwordx2 v[82:83], v82, s[12:15], s4 idxen
    s_mov_b64 exec, -1
    s_waitcnt lgkmcnt(3)
    v_lshlrev_b32_sdwa v122, 2, v46 dst_sel:DWORD dst_unused:UNUSED_PAD src0_sel:DWORD src1_sel:WORD_0
    v_lshlrev_b32_sdwa v123, 2, v47 dst_sel:DWORD dst_unused:UNUSED_PAD src0_sel:DWORD src1_sel:WORD_0
    v_lshlrev_b32_sdwa v124, 2, v48 dst_sel:DWORD dst_unused:UNUSED_PAD src0_sel:DWORD src1_sel:WORD_0
    v_lshlrev_b32_sdwa v125, 2, v49 dst_sel:DWORD dst_unused:UNUSED_PAD src0_sel:DWORD src1_sel:WORD_0
    s_mov_b64 exec, s[44:45]
    v_cmpx_gt_i32_e64 s[80:81], s25, v46
    ds_write_b32 v122, v40
    s_mov_b64 exec, s[44:45]
    v_cmpx_gt_i32_e64 s[82:83], s25, v47
    ds_write_b32 v123, v41
    s_mov_b64 exec, s[44:45]
    v_cmpx_gt_i32_e64 s[84:85], s25, v48
    ds_write_b32 v124, v42
    s_mov_b64 exec, s[44:45]
    v_cmpx_gt_i32_e64 s[86:87], s25, v49
    ds_write_b32 v125, v44
    s_and_b64 s[88:89], s[80:81], s[82:83]
    s_and_b64 exec, exec, s[84:85]
    s_and_b64 s[88:89], s[88:89], exec
    s_cmp_eq_u64 s[88:89], s[44:45]
    s_cbranch_scc1 Lc_no_14
    s_mov_b64 exec, s[44:45]
    s_movk_i32 s90, 382
    s_call_b64 s[88:89], Lc_ovf40
Lc_no_14:
    s_mov_b64 exec, -1
    buffer_load_dwordx3 v[40:42], v26, s[20:23], 0 offen
    buffer_load_dwordx2 v[44:45], v26, s[20:23], 0 offen offset:12
    s_mov_b64 exec, s[48:49]
    v_lshrrev_b32 v102, 6, v76
    v_cvt_f32_i32 v103, v76
    v_and_b32 v102, 0x3ff8, v102
    v_add_u32 v105, v102, v102
    ds_read_b64 v[100:101], v102 offset:23808
    ds_read_b128 v[96:99], v105 offset:3328
    v_fmaak_f32 v105, v103, v103, 0xddffc004
    v_fmaak_f32 v104, v105, v7, 0xb0001002
    v_mul_f32 v104, v104, v103
    v_cvt_pk_bf16_f32 v103, v103, v105
    s_waitcnt vmcnt(4)
    s_mov_b64 exec, s[46:47]
    v_bitop3_b32 v3, v3, v92, v93 bitop3:0xfe
    v_bitop3_b32 v3, v3, v94, v95 bitop3:0xfe
    v_pk_mul_f32 v[116:117], v[110:111], v[114:115] op_sel_hi:[1,0]
    v_fma_mix_f32 v118, v110, v114, 0 op_sel_hi:[1,0,0]
    v_fma_mix_f32 v119, v111, v114, 0 op_sel_hi:[1,0,0]
    v_dot2c_f32_bf16 v116, v107, v113
    v_dot2c_f32_bf16 v117, v109, v113
    v_dot2c_f32_bf16 v118, v106, v113
    v_dot2c_f32_bf16 v119, v108, v113
    v_lshlrev_b32 v120, 16, v78
    v_lshlrev_b32 v121, 16, v79
    v_pk_fma_f32 v[92:93], v[78:79], v[116:117], v[6:7] op_sel_hi:[1,1,0]
    v_pk_fma_f32 v[94:95], v[120:121], v[118:119], v[6:7] op_sel_hi:[1,1,0]
    v_lshl_add_u64 v[92:93], v[92:93], 0, v[4:5]
    v_lshl_add_u64 v[94:95], v[94:95], 0, v[4:5]
    ds_add_rtn_u64 v[92:93], v112, v[92:93] offset:34048
    ds_add_rtn_u64 v[94:95], v112, v[94:95] offset:44288
    s_mov_b64 exec, -1
    ds_read_b32 v73, v13 offset:41600
    s_waitcnt lgkmcnt(9)
    v_readlane_b32 s33, v8, 9
    v_and_b32 v84, 0x1ff, v72
    s_add_u32 s4, s32, 1200640
    s_bfm_b64 exec, s33, 0
    s_bitcmp1_b32 s33, 6
    s_cselect_b64 exec, -1, exec
    s_mov_b64 s[52:53], exec
    buffer_load_dwordx2 v[84:85], v84, s[12:15], s4 idxen
    s_mov_b64 exec, s[50:51]
    v_lshrrev_b32 v112, 6, v77
    v_cvt_f32_i32 v113, v77
    v_and_b32 v112, 0x3ff8, v112
    v_add_u32 v115, v112, v112
    ds_read_b64 v[110:111], v112 offset:23808
    ds_read_b128 v[106:109], v115 offset:3328
    v_fmaak_f32 v115, v113, v113, 0xddffc004
    v_fmaak_f32 v114, v115, v7, 0xb0001002
    v_mul_f32 v114, v114, v113
    v_cvt_pk_bf16_f32 v113, v113, v115
    s_waitcnt vmcnt(4) lgkmcnt(5)
    s_mov_b64 exec, s[48:49]
    v_bitop3_b32 v3, v3, v88, v89 bitop3:0xfe
    v_bitop3_b32 v3, v3, v90, v91 bitop3:0xfe
    v_pk_mul_f32 v[116:117], v[100:101], v[104:105] op_sel_hi:[1,0]
    v_fma_mix_f32 v118, v100, v104, 0 op_sel_hi:[1,0,0]
    v_fma_mix_f32 v119, v101, v104, 0 op_sel_hi:[1,0,0]
    v_dot2c_f32_bf16 v116, v97, v103
    v_dot2c_f32_bf16 v117, v99, v103
    v_dot2c_f32_bf16 v118, v96, v103
    v_dot2c_f32_bf16 v119, v98, v103
    v_lshlrev_b32 v120, 16, v80
    v_lshlrev_b32 v121, 16, v81
    v_pk_fma_f32 v[88:89], v[80:81], v[116:117], v[6:7] op_sel_hi:[1,1,0]
    v_pk_fma_f32 v[90:91], v[120:121], v[118:119], v[6:7] op_sel_hi:[1,1,0]
    v_lshl_add_u64 v[88:89], v[88:89], 0, v[4:5]
    v_lshl_add_u64 v[90:91], v[90:91], 0, v[4:5]
    ds_add_rtn_u64 v[88:89], v102, v[88:89] offset:34048
    ds_add_rtn_u64 v[90:91], v102, v[90:91] offset:44288
    s_mov_b64 exec, -1
    ds_read_b32 v74, v13 offset:45760
    s_waitcnt lgkmcnt(5)
    v_readlane_b32 s33, v8, 10
    v_and_b32 v86, 0x1ff, v73
    s_add_u32 s4, s32, 1257984
    s_bfm_b64 exec, s33, 0
    s_bitcmp1_b32 s33, 6
    s_cselect_b64 exec, -1, exec
    s_mov_b64 s[54:55], exec
    buffer_load_dwordx2 v[86:87], v86, s[12:15], s4 idxen
    s_mov_b64 exec, -1
    s_setprio 0
    s_mov_b64 exec, s[52:53]
    v_lshrrev_b32 v102, 6, v72
    v_cvt_f32_i32 v103, v72
    v_and_b32 v102, 0x3ff8, v102
    v_add_u32 v105, v102, v102
    ds_read_b64 v[100:101], v102 offset:23808
    ds_read_b128 v[96:99], v105 offset:3328
    v_fmaak_f32 v105, v103, v103, 0xddffc004
    v_fmaak_f32 v104, v105, v7, 0xb0001002
    v_mul_f32 v104, v104, v103
    v_cvt_pk_bf16_f32 v103, v103, v105
    s_mov_b64 exec, -1
    s_sub_u32 s26, s18, 192
    s_cmp_le_i32 s26, 0
    s_cbranch_scc1 Lc_rare_15
    v_lshlrev_b32_sdwa v56, 2, v55 dst_sel:DWORD dst_unused:UNUSED_PAD src0_sel:DWORD src1_sel:BYTE_0
    v_lshlrev_b32_sdwa v57, 2, v55 dst_sel:DWORD dst_unused:UNUSED_PAD src0_sel:DWORD src1_sel:BYTE_1
    v_lshlrev_b32_sdwa v58, 2, v55 dst_sel:DWORD dst_unused:UNUSED_PAD src0_sel:DWORD src1_sel:BYTE_2
    v_lshlrev_b32_sdwa v59, 2, v55 dst_sel:DWORD dst_unused:UNUSED_PAD src0_sel:DWORD src1_sel:BYTE_3
    v_cmpx_gt_i32_e64 s[36:37], s26, v1
    ds_add_rtn_u32 v56, v56, v11 offset:1536
    ds_add_rtn_u32 v57, v57, v11 offset:1536
    ds_add_rtn_u32 v58, v58, v11 offset:1536
    ds_add_rtn_u32 v59, v59, v11 offset:1536
    s_mov_b64 exec, -1
Lc_rare_15:
    s_waitcnt vmcnt(4) lgkmcnt(5)
    s_mov_b64 exec, s[50:51]
    v_bitop3_b32 v3, v3, v92, v93 bitop3:0xfe
    v_bitop3_b32 v3, v3, v94, v95 bitop3:0xfe
    v_pk_mul_f32 v[116:117], v[110:111], v[114:115] op_sel_hi:[1,0]
    v_fma_mix_f32 v118, v110, v114, 0 op_sel_hi:[1,0,0]
    v_fma_mix_f32 v119, v111, v114, 0 op_sel_hi:[1,0,0]
    v_dot2c_f32_bf16 v116, v107, v113
    v_dot2c_f32_bf16 v117, v109, v113
    v_dot2c_f32_bf16 v118, v106, v113
    v_dot2c_f32_bf16 v119, v108, v113
    v_lshlrev_b32 v120, 16, v82
    v_lshlrev_b32 v121, 16, v83
    v_pk_fma_f32 v[92:93], v[82:83], v[116:117], v[6:7] op_sel_hi:[1,1,0]
    v_pk_fma_f32 v[94:95], v[120:121], v[118:119], v[6:7] op_sel_hi:[1,1,0]
    v_lshl_add_u64 v[92:93], v[92:93], 0, v[4:5]
    v_lshl_add_u64 v[94:95], v[94:95], 0, v[4:5]
    ds_add_rtn_u64 v[92:93], v112, v[92:93] offset:34048
    ds_add_rtn_u64 v[94:95], v112, v[94:95] offset:44288
    s_mov_b64 exec, -1
    s_waitcnt lgkmcnt(4)
    v_readlane_b32 s33, v8, 11
    v_and_b32 v78, 0x1ff, v74
    s_add_u32 s4, s32, 1315328
    s_bfm_b64 exec, s33, 0
    s_bitcmp1_b32 s33, 6
    s_cselect_b64 exec, -1, exec
    s_mov_b64 s[46:47], exec
    buffer_load_dwordx2 v[78:79], v78, s[12:15], s4 idxen
    s_mov_b64 exec, -1
    s_cmp_le_u32 s18, 192
    s_cbranch_scc1 Lc_rare_16
    s_waitcnt lgkmcnt(2)
    v_lshlrev_b32_sdwa v122, 2, v56 dst_sel:DWORD dst_unused:UNUSED_PAD src0_sel:DWORD src1_sel:WORD_0
    v_lshlrev_b32_sdwa v123, 2, v57 dst_sel:DWORD dst_unused:UNUSED_PAD src0_sel:DWORD src1_sel:WORD_0
    v_lshlrev_b32_sdwa v124, 2, v58 dst_sel:DWORD dst_unused:UNUSED_PAD src0_sel:DWORD src1_sel:WORD_0
    v_lshlrev_b32_sdwa v125, 2, v59 dst_sel:DWORD dst_unused:UNUSED_PAD src0_sel:DWORD src1_sel:WORD_0
    s_mov_b64 exec, s[36:37]
    v_cmpx_gt_i32_e64 s[80:81], s25, v56
    ds_write_b32 v122, v50
    s_mov_b64 exec, s[36:37]
    v_cmpx_gt_i32_e64 s[82:83], s25, v57
    ds_write_b32 v123, v51
    s_mov_b64 exec, s[36:37]
    v_cmpx_gt_i32_e64 s[84:85], s25, v58
    ds_write_b32 v124, v52
    s_mov_b64 exec, s[36:37]
    v_cmpx_gt_i32_e64 s[86:87], s25, v59
    ds_write_b32 v125, v54
    s_and_b64 s[88:89], s[80:81], s[82:83]
    s_and_b64 exec, exec, s[84:85]
    s_and_b64 s[88:89], s[88:89], exec
    s_cmp_eq_u64 s[88:89], s[36:37]
    s_cbranch_scc1 Lc_no_17
    s_mov_b64 exec, s[36:37]
    s_movk_i32 s90, 382
    s_call_b64 s[88:89], Lc_ovf50
Lc_no_17:
    s_mov_b64 exec, -1
Lc_rare_16:
    buffer_load_dwordx3 v[50:52], v27, s[20:23], 0 offen
    buffer_load_dwordx2 v[54:55], v27, s[20:23], 0 offen offset:12
    s_mov_b64 exec, s[54:55]
    v_lshrrev_b32 v112, 6, v73
    v_cvt_f32_i32 v113, v73
    v_and_b32 v112, 0x3ff8, v112
    v_add_u32 v115, v112, v112
    ds_read_b64 v[110:111], v112 offset:23808
    ds_read_b128 v[106:109], v115 offset:3328
    v_fmaak_f32 v115, v113, v113, 0xddffc004
    v_fmaak_f32 v114, v115, v7, 0xb0001002
    v_mul_f32 v114, v114, v113
    v_cvt_pk_bf16_f32 v113, v113, v115
    s_waitcnt vmcnt(4) lgkmcnt(4)
    s_mov_b64 exec, s[52:53]
    v_bitop3_b32 v3, v3, v88, v89 bitop3:0xfe
    v_bitop3_b32 v3, v3, v90, v91 bitop3:0xfe
    v_pk_mul_f32 v[116:117], v[100:101], v[104:105] op_sel_hi:[1,0]
    v_fma_mix_f32 v118, v100, v104, 0 op_sel_hi:[1,0,0]
    v_fma_mix_f32 v119, v101, v104, 0 op_sel_hi:[1,0,0]
    v_dot2c_f32_bf16 v116, v97, v103
    v_dot2c_f32_bf16 v117, v99, v103
    v_dot2c_f32_bf16 v118, v96, v103
    v_dot2c_f32_bf16 v119, v98, v103
    v_lshlrev_b32 v120, 16, v84
    v_lshlrev_b32 v121, 16, v85
    v_pk_fma_f32 v[88:89], v[84:85], v[116:117], v[6:7] op_sel_hi:[1,1,0]
    v_pk_fma_f32 v[90:91], v[120:121], v[118:119], v[6:7] op_sel_hi:[1,1,0]
    v_lshl_add_u64 v[88:89], v[88:89], 0, v[4:5]
    v_lshl_add_u64 v[90:91], v[90:91], 0, v[4:5]
    ds_add_rtn_u64 v[88:89], v102, v[88:89] offset:34048
    ds_add_rtn_u64 v[90:91], v102, v[90:91] offset:44288
    s_mov_b64 exec, -1
    s_waitcnt lgkmcnt(4)
    s_barrier
    s_setprio 3
    ds_read_b32 v8, v9 offset:1536
    ds_read_b32 v75, v12 offset:0
    ds_read_b32 v76, v12 offset:4160
    s_waitcnt lgkmcnt(1)
    v_ashrrev_i32 v8, 16, v8
    v_med3_i32 v8, v8, 0, 64
    s_nop 0
    v_readlane_b32 s33, v8, 0
    v_and_b32 v80, 0x1ff, v75
    s_add_u32 s4, s32, 1369088
    s_bfm_b64 exec, s33, 0
    s_bitcmp1_b32 s33, 6
    s_cselect_b64 exec, -1, exec
    s_mov_b64 s[48:49], exec
    buffer_load_dwordx2 v[80:81], v80, s[12:15], s4 idxen
    s_mov_b64 exec, s[46:47]
    v_lshrrev_b32 v102, 6, v74
    v_cvt_f32_i32 v103, v74
    v_and_b32 v102, 0x3ff8, v102
    v_add_u32 v105, v102, v102
    ds_read_b64 v[100:101], v102 offset:23808
    ds_read_b128 v[96:99], v105 offset:3328
    v_fmaak_f32 v105, v103, v103, 0xddffc004
    v_fmaak_f32 v104, v105, v7, 0xb0001002
    v_mul_f32 v104, v104, v103
    v_cvt_pk_bf16_f32 v103, v103, v105
    s_waitcnt vmcnt(4)
    s_mov_b64 exec, s[54:55]
    v_bitop3_b32 v3, v3, v92, v93 bitop3:0xfe
    v_bitop3_b32 v3, v3, v94, v95 bitop3:0xfe
    v_pk_mul_f32 v[116:117], v[110:111], v[114:115] op_sel_hi:[1,0]
    v_fma_mix_f32 v118, v110, v114, 0 op_sel_hi:[1,0,0]
    v_fma_mix_f32 v119, v111, v114, 0 op_sel_hi:[1,0,0]
    v_dot2c_f32_bf16 v116, v107, v113
    v_dot2c_f32_bf16 v117, v109, v113
    v_dot2c_f32_bf16 v118, v106, v113
    v_dot2c_f32_bf16 v119, v108, v113
    v_lshlrev_b32 v120, 16, v86
    v_lshlrev_b32 v121, 16, v87
    v_pk_fma_f32 v[92:93], v[86:87], v[116:117], v[6:7] op_sel_hi:[1,1,0]
    v_pk_fma_f32 v[94:95], v[120:121], v[118:119], v[6:7] op_sel_hi:[1,1,0]
    v_lshl_add_u64 v[92:93], v[92:93], 0, v[4:5]
    v_lshl_add_u64 v[94:95], v[94:95], 0, v[4:5]
    ds_add_rtn_u64 v[92:93], v112, v[92:93] offset:34048
    ds_add_rtn_u64 v[94:95], v112, v[94:95] offset:44288
    s_mov_b64 exec, -1
    ds_read_b32 v77, v12 offset:8320
    s_waitcnt lgkmcnt(5)
    v_readlane_b32 s33, v8, 1
    v_and_b32 v82, 0x1ff, v76
    s_add_u32 s4, s32, 1426432
    s_bfm_b64 exec, s33, 0
    s_bitcmp1_b32 s33, 6
    s_cselect_b64 exec, -1, exec
    s_mov_b64 s[50:51], exec
    buffer_load_dwordx2 v[82:83], v82, s[12:15], s4 idxen
    s_mov_b64 exec, s[48:49]
    v_lshrrev_b32 v112, 6, v75
    v_cvt_f32_i32 v113, v75
    v_and_b32 v112, 0x3ff8, v112
    v_add_u32 v115, v112, v112
    ds_read_b64 v[110:111], v112 offset:23808
    ds_read_b128 v[106:109], v115 offset:3328
    v_fmaak_f32 v115, v113, v113, 0xddffc004
    v_fmaak_f32 v114, v115, v7, 0xb0001002
    v_mul_f32 v114, v114, v113
    v_cvt_pk_bf16_f32 v113, v113, v115
    s_waitcnt vmcnt(4) lgkmcnt(5)
    s_mov_b64 exec, s[46:47]
    v_bitop3_b32 v3, v3, v88, v89 bitop3:0xfe
    v_bitop3_b32 v3, v3, v90, v91 bitop3:0xfe
    v_pk_mul_f32 v[116:117], v[100:101], v[104:105] op_sel_hi:[1,0]
    v_fma_mix_f32 v118, v100, v104, 0 op_sel_hi:[1,0,0]
    v_fma_mix_f32 v119, v101, v104, 0 op_sel_hi:[1,0,0]
    v_dot2c_f32_bf16 v116, v97, v103
    v_dot2c_f32_bf16 v117, v99, v103
    v_dot2c_f32_bf16 v118, v96, v103
    v_dot2c_f32_bf16 v119, v98, v103
    v_lshlrev_b32 v120, 16, v78
    v_lshlrev_b32 v121, 16, v79
    v_pk_fma_f32 v[88:89], v[78:79], v[116:117], v[6:7] op_sel_hi:[1,1,0]
    v_pk_fma_f32 v[90:91], v[120:121], v[118:119], v[6:7] op_sel_hi:[1,1,0]
    v_lshl_add_u64 v[88:89], v[88:89], 0, v[4:5]
    v_lshl_add_u64 v[90:91], v[90:91], 0, v[4:5]
    ds_add_rtn_u64 v[88:89], v102, v[88:89] offset:34048
    ds_add_rtn_u64 v[90:91], v102, v[90:91] offset:44288
    s_mov_b64 exec, -1
    ds_read_b32 v72, v12 offset:12480
    s_waitcnt lgkmcnt(5)
    v_readlane_b32 s33, v8, 2
    v_and_b32 v84, 0x1ff, v77
    s_add_u32 s4, s32, 1483776
    s_bfm_b64 exec, s33, 0
    s_bitcmp1_b32 s33, 6
    s_cselect_b64 exec, -1, exec
    s_mov_b64 s[52:53], exec
    buffer_load_dwordx2 v[84:85], v84, s[12:15], s4 idxen
    s_mov_b64 exec, s[50:51]
    v_lshrrev_b32 v102, 6, v76
    v_cvt_f32_i32 v103, v76
    v_and_b32 v102, 0x3ff8, v102
    v_add_u32 v105, v102, v102
    ds_read_b64 v[100:101], v102 offset:23808
    ds_read_b128 v[96:99], v105 offset:3328
    v_fmaak_f32 v105, v103, v103, 0xddffc004
    v_fmaak_f32 v104, v105, v7, 0xb0001002
    v_mul_f32 v104, v104, v103
    v_cvt_pk_bf16_f32 v103, v103, v105
    s_mov_b64 exec, -1
    s_sub_u32 s26, s19, 0
    v_lshlrev_b32_sdwa v46, 2, v45 dst_sel:DWORD dst_unused:UNUSED_PAD src0_sel:DWORD src1_sel:BYTE_0
    v_lshlrev_b32_sdwa v47, 2, v45 dst_sel:DWORD dst_unused:UNUSED_PAD src0_sel:DWORD src1_sel:BYTE_1
    v_lshlrev_b32_sdwa v48, 2, v45 dst_sel:DWORD dst_unused:UNUSED_PAD src0_sel:DWORD src1_sel:BYTE_2
    v_lshlrev_b32_sdwa v49, 2, v45 dst_sel:DWORD dst_unused:UNUSED_PAD src0_sel:DWORD src1_sel:BYTE_3
    v_cmpx_gt_i32_e64 s[38:39], s26, v1
    ds_add_rtn_u32 v46, v46, v11 offset:2304
    ds_add_rtn_u32 v47, v47, v11 offset:2304
    ds_add_rtn_u32 v48, v48, v11 offset:2304
    ds_add_rtn_u32 v49, v49, v11 offset:2304
    s_mov_b64 exec, -1
    s_waitcnt vmcnt(2) lgkmcnt(9)
    s_mov_b64 exec, s[48:49]
    v_bitop3_b32 v3, v3, v92, v93 bitop3:0xfe
    v_bitop3_b32 v3, v3, v94, v95 bitop3:0xfe
    v_pk_mul_f32 v[116:117], v[110:111], v[114:115] op_sel_hi:[1,0]
    v_fma_mix_f32 v118, v110, v114, 0 op_sel_hi:[1,0,0]
    v_fma_mix_f32 v119, v111, v114, 0 op_sel_hi:[1,0,0]
    v_dot2c_f32_bf16 v116, v107, v113
    v_dot2c_f32_bf16 v117, v109, v113
    v_dot2c_f32_bf16 v118, v106, v113
    v_dot2c_f32_bf16 v119, v108, v113
    v_lshlrev_b32 v120, 16, v80
    v_lshlrev_b32 v121, 16, v81
    v_pk_fma_f32 v[92:93], v[80:81], v[116:117], v[6:7] op_sel_hi:[1,1,0]
    v_pk_fma_f32 v[94:95], v[120:121], v[118:119], v[6:7] op_sel_hi:[1,1,0]
    v_lshl_add_u64 v[92:93], v[92:93], 0, v[4:5]
    v_lshl_add_u64 v[94:95], v[94:95], 0, v[4:5]
    ds_add_rtn_u64 v[92:93], v112, v[92:93] offset:34048
    ds_add_rtn_u64 v[94:95], v112, v[94:95] offset:44288
    s_mov_b64 exec, -1
    ds_read_b32 v73, v12 offset:16640
    s_waitcnt lgkmcnt(9)
    v_readlane_b32 s33, v8, 3
    v_and_b32 v86, 0x1ff, v72
    s_add_u32 s4, s32, 1541120
    s_bfm_b64 exec, s33, 0
    s_bitcmp1_b32 s33, 6
    s_cselect_b64 exec, -1, exec
    s_mov_b64 s[54:55], exec
    buffer_load_dwordx2 v[86:87], v86, s[12:15], s4 idxen
    s_mov_b64 exec, -1
    s_waitcnt lgkmcnt(3)
    v_lshlrev_b32_sdwa v122, 2, v46 dst_sel:DWORD dst_unused:UNUSED_PAD src0_sel:DWORD src1_sel:WORD_0
    v_lshlrev_b32_sdwa v123, 2, v47 dst_sel:DWORD dst_unused:UNUSED_PAD src0_sel:DWORD src1_sel:WORD_0
    v_lshlrev_b32_sdwa v124, 2, v48 dst_sel:DWORD dst_unused:UNUSED_PAD src0_sel:DWORD src1_sel:WORD_0
    v_lshlrev_b32_sdwa v125, 2, v49 dst_sel:DWORD dst_unused:UNUSED_PAD src0_sel:DWORD src1_sel:WORD_0
    s_mov_b64 exec, s[38:39]
    v_cmpx_gt_i32_e64 s[80:81], s25, v46
    ds_write_b32 v122, v40
    s_mov_b64 exec, s[38:39]
    v_cmpx_gt_i32_e64 s[82:83], s25, v47
    ds_write_b32 v123, v41
    s_mov_b64 exec, s[38:39]
    v_cmpx_gt_i32_e64 s[84:85], s25, v48
    ds_write_b32 v124, v42
    s_mov_b64 exec, s[38:39]
    v_cmpx_gt_i32_e64 s[86:87], s25, v49
    ds_write_b32 v125, v44
    s_and_b64 s[88:89], s[80:81], s[82:83]
    s_and_b64 exec, exec, s[84:85]
    s_and_b64 s[88:89], s[88:89], exec
    s_cmp_eq_u64 s[88:89], s[38:39]
    s_cbranch_scc1 Lc_no_18
    s_mov_b64 exec, s[38:39]
    s_movk_i32 s90, 573
    s_call_b64 s[88:89], Lc_ovf40
Lc_no_18:
    s_mov_b64 exec, -1
    buffer_load_dwordx3 v[40:42], v28, s[20:23], 0 offen
    buffer_load_dwordx2 v[44:45], v28, s[20:23], 0 offen offset:12
    s_mov_b64 exec, s[52:53]
    v_lshrrev_b32 v112, 6, v77
    v_cvt_f32_i32 v113, v77
    v_and_b32 v112, 0x3ff8, v112
    v_add_u32 v115, v112, v112
    ds_read_b64 v[110:111], v112 offset:23808
    ds_read_b128 v[106:109], v115 offset:3328
    v_fmaak_f32 v115, v113, v113, 0xddffc004
    v_fmaak_f32 v114, v115, v7, 0xb0001002
    v_mul_f32 v114, v114, v113
    v_cvt_pk_bf16_f32 v113, v113, v115
    s_waitcnt vmcnt(4)
    s_mov_b64 exec, s[50:51]
    v_bitop3_b32 v3, v3, v88, v89 bitop3:0xfe
    v_bitop3_b32 v3, v3, v90, v91 bitop3:0xfe
    v_pk_mul_f32 v[116:117], v[100:101], v[104:105] op_sel_hi:[1,0]
    v_fma_mix_f32 v118, v100, v104, 0 op_sel_hi:[1,0,0]
    v_fma_mix_f32 v119, v101, v104, 0 op_sel_hi:[1,0,0]
    v_dot2c_f32_bf16 v116, v97, v103
    v_dot2c_f32_bf16 v117, v99, v103
    v_dot2c_f32_bf16 v118, v96, v103
    v_dot2c_f32_bf16 v119, v98, v103
    v_lshlrev_b32 v120, 16, v82
    v_lshlrev_b32 v121, 16, v83
    v_pk_fma_f32 v[88:89], v[82:83], v[116:117], v[6:7] op_sel_hi:[1,1,0]
    v_pk_fma_f32 v[90:91], v[120:121], v[118:119], v[6:7] op_sel_hi:[1,1,0]
    v_lshl_add_u64 v[88:89], v[88:89], 0, v[4:5]
    v_lshl_add_u64 v[90:91], v[90:91], 0, v[4:5]
    ds_add_rtn_u64 v[88:89], v102, v[88:89] offset:34048
    ds_add_rtn_u64 v[90:91], v102, v[90:91] offset:44288
    s_mov_b64 exec, -1
    ds_read_b32 v74, v12 offset:20800
    s_waitcnt lgkmcnt(9)
    v_readlane_b32 s33, v8, 4
    v_and_b32 v78, 0x1ff, v73
    s_add_u32 s4, s32, 1598464
    s_bfm_b64 exec, s33, 0
    s_bitcmp1_b32 s33, 6
    s_cselect_b64 exec, -1, exec
    s_mov_b64 s[46:47], exec
    buffer_load_dwordx2 v[78:79], v78, s[12:15], s4 idxen
    s_mov_b64 exec, -1
    s_setprio 2
    s_mov_b64 exec, s[54:55]
    v_lshrrev_b32 v102, 6, v72
    v_cvt_f32_i32 v103, v72
    v_and_b32 v102, 0x3ff8, v102
    v_add_u32 v105, v102, v102
    ds_read_b64 v[100:101], v102 offset:23808
    ds_read_b128 v[96:99], v105 offset:3328
    v_fmaak_f32 v105, v103, v103, 0xddffc004
    v_fmaak_f32 v104, v105, v7, 0xb0001002
    v_mul_f32 v104, v104, v103
    v_cvt_pk_bf16_f32 v103, v103, v105
    s_waitcnt vmcnt(4) lgkmcnt(5)
    s_mov_b64 exec, s[52:53]
    v_bitop3_b32 v3, v3, v92, v93 bitop3:0xfe
    v_bitop3_b32 v3, v3, v94, v95 bitop3:0xfe
    v_pk_mul_f32 v[116:117], v[110:111], v[114:115] op_sel_hi:[1,0]
    v_fma_mix_f32 v118, v110, v114, 0 op_sel_hi:[1,0,0]
    v_fma_mix_f32 v119, v111, v114, 0 op_sel_hi:[1,0,0]
    v_dot2c_f32_bf16 v116, v107, v113
    v_dot2c_f32_bf16 v117, v109, v113
    v_dot2c_f32_bf16 v118, v106, v113
    v_dot2c_f32_bf16 v119, v108, v113
    v_lshlrev_b32 v120, 16, v84
    v_lshlrev_b32 v121, 16, v85
    v_pk_fma_f32 v[92:93], v[84:85], v[116:117], v[6:7] op_sel_hi:[1,1,0]
    v_pk_fma_f32 v[94:95], v[120:121], v[118:119], v[6:7] op_sel_hi:[1,1,0]
    v_lshl_add_u64 v[92:93], v[92:93], 0, v[4:5]
    v_lshl_add_u64 v[94:95], v[94:95], 0, v[4:5]
    ds_add_rtn_u64 v[92:93], v112, v[92:93] offset:34048
    ds_add_rtn_u64 v[94:95], v112, v[94:95] offset:44288
    s_mov_b64 exec, -1
    ds_read_b32 v75, v12 offset:24960
    s_waitcnt lgkmcnt(5)
    v_readlane_b32 s33, v8, 5
    v_and_b32 v80, 0x1ff, v74
    s_add_u32 s4, s32, 1655808
    s_bfm_b64 exec, s33, 0
    s_bitcmp1_b32 s33, 6
    s_cselect_b64 exec, -1, exec
    s_mov_b64 s[48:49], exec
    buffer_load_dwordx2 v[80:81], v80, s[12:15], s4 idxen
    s_mov_b64 exec, -1
    s_sub_u32 s26, s19, 64
    v_lshlrev_b32_sdwa v56, 2, v55 dst_sel:DWORD dst_unused:UNUSED_PAD src0_sel:DWORD src1_sel:BYTE_0
    v_lshlrev_b32_sdwa v57, 2, v55 dst_sel:DWORD dst_unused:UNUSED_PAD src0_sel:DWORD src1_sel:BYTE_1
    v_lshlrev_b32_sdwa v58, 2, v55 dst_sel:DWORD dst_unused:UNUSED_PAD src0_sel:DWORD src1_sel:BYTE_2
    v_lshlrev_b32_sdwa v59, 2, v55 dst_sel:DWORD dst_unused:UNUSED_PAD src0_sel:DWORD src1_sel:BYTE_3
    v_cmpx_gt_i32_e64 s[40:41], s26, v1
    ds_add_rtn_u32 v56, v56, v11 offset:2304
    ds_add_rtn_u32 v57, v57, v11 offset:2304
    ds_add_rtn_u32 v58, v58, v11 offset:2304
    ds_add_rtn_u32 v59, v59, v11 offset:2304
    s_mov_b64 exec, s[46:47]
    v_lshrrev_b32 v112, 6, v73
    v_cvt_f32_i32 v113, v73
    v_and_b32 v112, 0x3ff8, v112
    v_add_u32 v115, v112, v112
    ds_read_b64 v[110:111], v112 offset:23808
    ds_read_b128 v[106:109], v115 offset:3328
    v_fmaak_f32 v115, v113, v113, 0xddffc004
    v_fmaak_f32 v114, v115, v7, 0xb0001002
    v_mul_f32 v114, v114, v113
    v_cvt_pk_bf16_f32 v113, v113, v115
    s_mov_b64 exec, -1
    s_waitcnt lgkmcnt(2)
    v_lshlrev_b32_sdwa v122, 2, v56 dst_sel:DWORD dst_unused:UNUSED_PAD src0_sel:DWORD src1_sel:WORD_0
    v_lshlrev_b32_sdwa v123, 2, v57 dst_sel:DWORD dst_unused:UNUSED_PAD src0_sel:DWORD src1_sel:WORD_0
    v_lshlrev_b32_sdwa v124, 2, v58 dst_sel:DWORD dst_unused:UNUSED_PAD src0_sel:DWORD src1_sel:WORD_0
    v_lshlrev_b32_sdwa v125, 2, v59 dst_sel:DWORD dst_unused:UNUSED_PAD src0_sel:DWORD src1_sel:WORD_0
    s_mov_b64 exec, s[40:41]
    v_cmpx_gt_i32_e64 s[80:81], s25, v56
    ds_write_b32 v122, v50
    s_mov_b64 exec, s[40:41]
    v_cmpx_gt_i32_e64 s[82:83], s25, v57
    ds_write_b32 v123, v51
    s_mov_b64 exec, s[40:41]
    v_cmpx_gt_i32_e64 s[84:85], s25, v58
    ds_write_b32 v124, v52
    s_mov_b64 exec, s[40:41]
    v_cmpx_gt_i32_e64 s[86:87], s25, v59
    ds_write_b32 v125, v54
    s_and_b64 s[88:89], s[80:81], s[82:83]
    s_and_b64 exec, exec, s[84:85]
    s_and_b64 s[88:89], s[88:89], exec
    s_cmp_eq_u64 s[88:89], s[40:41]
    s_cbranch_scc1 Lc_no_19
    s_mov_b64 exec, s[40:41]
    s_movk_i32 s90, 573
    s_call_b64 s[88:89], Lc_ovf50
Lc_no_19:
    s_mov_b64 exec, -1
    buffer_load_dwordx3 v[50:52], v29, s[20:23], 0 offen
    buffer_load_dwordx2 v[54:55], v29, s[20:23], 0 offen offset:12
    s_waitcnt vmcnt(6)
    s_mov_b64 exec, s[54:55]
    v_bitop3_b32 v3, v3, v88, v89 bitop3:0xfe
    v_bitop3_b32 v3, v3, v90, v91 bitop3:0xfe
    v_pk_mul_f32 v[116:117], v[100:101], v[104:105] op_sel_hi:[1,0]
    v_fma_mix_f32 v118, v100, v104, 0 op_sel_hi:[1,0,0]
    v_fma_mix_f32 v119, v101, v104, 0 op_sel_hi:[1,0,0]
    v_dot2c_f32_bf16 v116, v97, v103
    v_dot2c_f32_bf16 v117, v99, v103
    v_dot2c_f32_bf16 v118, v96, v103
    v_dot2c_f32_bf16 v119, v98, v103
    v_lshlrev_b32 v120, 16, v86
    v_lshlrev_b32 v121, 16, v87
    v_pk_fma_f32 v[88:89], v[86:87], v[116:117], v[6:7] op_sel_hi:[1,1,0]
    v_pk_fma_f32 v[90:91], v[120:121], v[118:119], v[6:7] op_sel_hi:[1,1,0]
    v_lshl_add_u64 v[88:89], v[88:89], 0, v[4:5]
    v_lshl_add_u64 v[90:91], v[90:91], 0, v[4:5]
    ds_add_rtn_u64 v[88:89], v102, v[88:89] offset:34048
    ds_add_rtn_u64 v[90:91], v102, v[90:91] offset:44288
    s_mov_b64 exec, -1
    ds_read_b32 v76, v12 offset:29120
    v_readlane_b32 s33, v8, 6
    v_and_b32 v82, 0x1ff, v75
    s_add_u32 s4, s32, 1713152
    s_bfm_b64 exec, s33, 0
    s_bitcmp1_b32 s33, 6
    s_cselect_b64 exec, -1, exec
    s_mov_b64 s[50:51], exec
    buffer_load_dwordx2 v[82:83], v82, s[12:15], s4 idxen
    s_mov_b64 exec, s[48:49]
    v_lshrrev_b32 v102, 6, v74
    v_cvt_f32_i32 v103, v74
    v_and_b32 v102, 0x3ff8, v102
    v_add_u32 v105, v102, v102
    ds_read_b64 v[100:101], v102 offset:23808
    ds_read_b128 v[96:99], v105 offset:3328
    v_fmaak_f32 v105, v103, v103, 0xddffc004
    v_fmaak_f32 v104, v105, v7, 0xb0001002
    v_mul_f32 v104, v104, v103
    v_cvt_pk_bf16_f32 v103, v103, v105
    s_waitcnt vmcnt(4) lgkmcnt(9)
    s_mov_b64 exec, s[46:47]
    v_bitop3_b32 v3, v3, v92, v93 bitop3:0xfe
    v_bitop3_b32 v3, v3, v94, v95 bitop3:0xfe
    v_pk_mul_f32 v[116:117], v[110:111], v[114:115] op_sel_hi:[1,0]
    v_fma_mix_f32 v118, v110, v114, 0 op_sel_hi:[1,0,0]
    v_fma_mix_f32 v119, v111, v114, 0 op_sel_hi:[1,0,0]
    v_dot2c_f32_bf16 v116, v107, v113
    v_dot2c_f32_bf16 v117, v109, v113
    v_dot2c_f32_bf16 v118, v106, v113
    v_dot2c_f32_bf16 v119, v108, v113
    v_lshlrev_b32 v120, 16, v78
    v_lshlrev_b32 v121, 16, v79
    v_pk_fma_f32 v[92:93], v[78:79], v[116:117], v[6:7] op_sel_hi:[1,1,0]
    v_pk_fma_f32 v[94:95], v[120:121], v[118:119], v[6:7] op_sel_hi:[1,1,0]
    v_lshl_add_u64 v[92:93], v[92:93], 0, v[4:5]
    v_lshl_add_u64 v[94:95], v[94:95], 0, v[4:5]
    ds_add_rtn_u64 v[92:93], v112, v[92:93] offset:34048
    ds_add_rtn_u64 v[94:95], v112, v[94:95] offset:44288
    s_mov_b64 exec, -1
    ds_read_b32 v77, v12 offset:33280
    s_waitcnt lgkmcnt(5)
    v_readlane_b32 s33, v8, 7
    v_and_b32 v84, 0x1ff, v76
    s_add_u32 s4, s32, 1770496
    s_bfm_b64 exec, s33, 0
    s_bitcmp1_b32 s33, 6
    s_cselect_b64 exec, -1, exec
    s_mov_b64 s[52:53], exec
    buffer_load_dwordx2 v[84:85], v84, s[12:15], s4 idxen
    s_mov_b64 exec, -1
    s_setprio 1
    s_mov_b64 exec, s[50:51]
    v_lshrrev_b32 v112, 6, v75
    v_cvt_f32_i32 v113, v75
    v_and_b32 v112, 0x3ff8, v112
    v_add_u32 v115, v112, v112
    ds_read_b64 v[110:111], v112 offset:23808
    ds_read_b128 v[106:109], v115 offset:3328
    v_fmaak_f32 v115, v113, v113, 0xddffc004
    v_fmaak_f32 v114, v115, v7, 0xb0001002
    v_mul_f32 v114, v114, v113
    v_cvt_pk_bf16_f32 v113, v113, v115
    s_mov_b64 exec, -1
    s_sub_u32 s26, s19, 128
    v_lshlrev_b32_sdwa v46, 2, v45 dst_sel:DWORD dst_unused:UNUSED_PAD src0_sel:DWORD src1_sel:BYTE_0
    v_lshlrev_b32_sdwa v47, 2, v45 dst_sel:DWORD dst_unused:UNUSED_PAD src0_sel:DWORD src1_sel:BYTE_1
    v_lshlrev_b32_sdwa v48, 2, v45 dst_sel:DWORD dst_unused:UNUSED_PAD src0_sel:DWORD src1_sel:BYTE_2
    v_lshlrev_b32_sdwa v49, 2, v45 dst_sel:DWORD dst_unused:UNUSED_PAD src0_sel:DWORD src1_sel:BYTE_3
    v_cmpx_gt_i32_e64 s[42:43], s26, v1
    ds_add_rtn_u32 v46, v46, v11 offset:2304
    ds_add_rtn_u32 v47, v47, v11 offset:2304
    ds_add_rtn_u32 v48, v48, v11 offset:2304
    ds_add_rtn_u32 v49, v49, v11 offset:2304
    s_mov_b64 exec, -1
    s_waitcnt vmcnt(4) lgkmcnt(9)
    s_mov_b64 exec, s[48:49]
    v_bitop3_b32 v3, v3, v88, v89 bitop3:0xfe
    v_bitop3_b32 v3, v3, v90, v91 bitop3:0xfe
    v_pk_mul_f32 v[116:117], v[100:101], v[104:105] op_sel_hi:[1,0]
    v_fma_mix_f32 v118, v100, v104, 0 op_sel_hi:[1,0,0]
    v_fma_mix_f32 v119, v101, v104, 0 op_sel_hi:[1,0,0]
    v_dot2c_f32_bf16 v116, v97, v103
    v_dot2c_f32_bf16 v117, v99, v103
    v_dot2c_f32_bf16 v118, v96, v103
    v_dot2c_f32_bf16 v119, v98, v103
    v_lshlrev_b32 v120, 16, v80
    v_lshlrev_b32 v121, 16, v81
    v_pk_fma_f32 v[88:89], v[80:81], v[116:117], v[6:7] op_sel_hi:[1,1,0]
    v_pk_fma_f32 v[90:91], v[120:121], v[118:119], v[6:7] op_sel_hi:[1,1,0]
    v_lshl_add_u64 v[88:89], v[88:89], 0, v[4:5]
    v_lshl_add_u64 v[90:91], v[90:91], 0, v[4:5]
    ds_add_rtn_u64 v[88:89], v102, v[88:89] offset:34048
    ds_add_rtn_u64 v[90:91], v102, v[90:91] offset:44288
    s_mov_b64 exec, -1
    ds_read_b32 v72, v12 offset:37440
    s_waitcnt lgkmcnt(9)
    v_readlane_b32 s33, v8, 8
    v_and_b32 v86, 0x1ff, v77
    s_add_u32 s4, s32, 1827840
    s_bfm_b64 exec, s33, 0
    s_bitcmp1_b32 s33, 6
    s_cselect_b64 exec, -1, exec
    s_mov_b64 s[54:55], exec
    buffer_load_dwordx2 v[86:87], v86, s[12:15], s4 idxen
    s_mov_b64 exec, -1
    s_waitcnt lgkmcnt(3)
    v_lshlrev_b32_sdwa v122, 2, v46 dst_sel:DWORD dst_unused:UNUSED_PAD src0_sel:DWORD src1_sel:WORD_0
    v_lshlrev_b32_sdwa v123, 2, v47 dst_sel:DWORD dst_unused:UNUSED_PAD src0_sel:DWORD src1_sel:WORD_0
    v_lshlrev_b32_sdwa v124, 2, v48 dst_sel:DWORD dst_unused:UNUSED_PAD src0_sel:DWORD src1_sel:WORD_0
    v_lshlrev_b32_sdwa v125, 2, v49 dst_sel:DWORD dst_unused:UNUSED_PAD src0_sel:DWORD src1_sel:WORD_0
    s_mov_b64 exec, s[42:43]
    v_cmpx_gt_i32_e64 s[80:81], s25, v46
    ds_write_b32 v122, v40
    s_mov_b64 exec, s[42:43]
    v_cmpx_gt_i32_e64 s[82:83], s25, v47
    ds_write_b32 v123, v41
    s_mov_b64 exec, s[42:43]
    v_cmpx_gt_i32_e64 s[84:85], s25, v48
    ds_write_b32 v124, v42
    s_mov_b64 exec, s[42:43]
    v_cmpx_gt_i32_e64 s[86:87], s25, v49
    ds_write_b32 v125, v44
    s_and_b64 s[88:89], s[80:81], s[82:83]
    s_and_b64 exec, exec, s[84:85]
    s_and_b64 s[88:89], s[88:89], exec
    s_cmp_eq_u64 s[88:89], s[42:43]
    s_cbranch_scc1 Lc_no_20
    s_mov_b64 exec, s[42:43]
    s_movk_i32 s90, 573
    s_call_b64 s[88:89], Lc_ovf40
Lc_no_20:
    s_mov_b64 exec, s[52:53]
    v_lshrrev_b32 v102, 6, v76
    v_cvt_f32_i32 v103, v76
    v_and_b32 v102, 0x3ff8, v102
    v_add_u32 v105, v102, v102
    ds_read_b64 v[100:101], v102 offset:23808
    ds_read_b128 v[96:99], v105 offset:3328
    v_fmaak_f32 v105, v103, v103, 0xddffc004
    v_fmaak_f32 v104, v105, v7, 0xb0001002
    v_mul_f32 v104, v104, v103
    v_cvt_pk_bf16_f32 v103, v103, v105
    s_waitcnt vmcnt(2)
    s_mov_b64 exec, s[50:51]
    v_bitop3_b32 v3, v3, v92, v93 bitop3:0xfe
    v_bitop3_b32 v3, v3, v94, v95 bitop3:0xfe
    v_pk_mul_f32 v[116:117], v[110:111], v[114:115] op_sel_hi:[1,0]
    v_fma_mix_f32 v118, v110, v114, 0 op_sel_hi:[1,0,0]
    v_fma_mix_f32 v119, v111, v114, 0 op_sel_hi:[1,0,0]
    v_dot2c_f32_bf16 v116, v107, v113
    v_dot2c_f32_bf16 v117, v109, v113
    v_dot2c_f32_bf16 v118, v106, v113
    v_dot2c_f32_bf16 v119, v108, v113
    v_lshlrev_b32 v120, 16, v82
    v_lshlrev_b32 v121, 16, v83
    v_pk_fma_f32 v[92:93], v[82:83], v[116:117], v[6:7] op_sel_hi:[1,1,0]
    v_pk_fma_f32 v[94:95], v[120:121], v[118:119], v[6:7] op_sel_hi:[1,1,0]
    v_lshl_add_u64 v[92:93], v[92:93], 0, v[4:5]
    v_lshl_add_u64 v[94:95], v[94:95], 0, v[4:5]
    ds_add_rtn_u64 v[92:93], v112, v[92:93] offset:34048
    ds_add_rtn_u64 v[94:95], v112, v[94:95] offset:44288
    s_mov_b64 exec, -1
    ds_read_b32 v73, v12 offset:41600
    s_waitcnt lgkmcnt(9)
    v_readlane_b32 s33, v8, 9
    v_and_b32 v78, 0x1ff, v72
    s_add_u32 s4, s32, 1885184
    s_bfm_b64 exec, s33, 0
    s_bitcmp1_b32 s33, 6
    s_cselect_b64 exec, -1, exec
    s_mov_b64 s[46:47], exec
    buffer_load_dwordx2 v[78:79], v78, s[12:15], s4 idxen
    s_mov_b64 exec, s[54:55]
    v_lshrrev_b32 v112, 6, v77
    v_cvt_f32_i32 v113, v77
    v_and_b32 v112, 0x3ff8, v112
    v_add_u32 v115, v112, v112
    ds_read_b64 v[110:111], v112 offset:23808
    ds_read_b128 v[106:109], v115 offset:3328
    v_fmaak_f32 v115, v113, v113, 0xddffc004
    v_fmaak_f32 v114, v115, v7, 0xb0001002
    v_mul_f32 v114, v114, v113
    v_cvt_pk_bf16_f32 v113, v113, v115
    s_waitcnt vmcnt(2) lgkmcnt(5)
    s_mov_b64 exec, s[52:53]
    v_bitop3_b32 v3, v3, v88, v89 bitop3:0xfe
    v_bitop3_b32 v3, v3, v90, v91 bitop3:0xfe
    v_pk_mul_f32 v[116:117], v[100:101], v[104:105] op_sel_hi:[1,0]
    v_fma_mix_f32 v118, v100, v104, 0 op_sel_hi:[1,0,0]
    v_fma_mix_f32 v119, v101, v104, 0 op_sel_hi:[1,0,0]
    v_dot2c_f32_bf16 v116, v97, v103
    v_dot2c_f32_bf16 v117, v99, v103
    v_dot2c_f32_bf16 v118, v96, v103
    v_dot2c_f32_bf16 v119, v98, v103
    v_lshlrev_b32 v120, 16, v84
    v_lshlrev_b32 v121, 16, v85
    v_pk_fma_f32 v[88:89], v[84:85], v[116:117], v[6:7] op_sel_hi:[1,1,0]
    v_pk_fma_f32 v[90:91], v[120:121], v[118:119], v[6:7] op_sel_hi:[1,1,0]
    v_lshl_add_u64 v[88:89], v[88:89], 0, v[4:5]
    v_lshl_add_u64 v[90:91], v[90:91], 0, v[4:5]
    ds_add_rtn_u64 v[88:89], v102, v[88:89] offset:34048
    ds_add_rtn_u64 v[90:91], v102, v[90:91] offset:44288
    s_mov_b64 exec, -1
    ds_read_b32 v74, v12 offset:45760
    s_waitcnt lgkmcnt(5)
    v_readlane_b32 s33, v8, 10
    v_and_b32 v80, 0x1ff, v73
    s_add_u32 s4, s32, 1942528
    s_bfm_b64 exec, s33, 0
    s_bitcmp1_b32 s33, 6
    s_cselect_b64 exec, -1, exec
    s_mov_b64 s[48:49], exec
    buffer_load_dwordx2 v[80:81], v80, s[12:15], s4 idxen
    s_mov_b64 exec, -1
    s_setprio 0
    s_mov_b64 exec, s[46:47]
    v_lshrrev_b32 v102, 6, v72
    v_cvt_f32_i32 v103, v72
    v_and_b32 v102, 0x3ff8, v102
    v_add_u32 v105, v102, v102
    ds_read_b64 v[100:101], v102 offset:23808
    ds_read_b128 v[96:99], v105 offset:3328
    v_fmaak_f32 v105, v103, v103, 0xddffc004
    v_fmaak_f32 v104, v105, v7, 0xb0001002
    v_mul_f32 v104, v104, v103
    v_cvt_pk_bf16_f32 v103, v103, v105
    s_mov_b64 exec, -1
    s_sub_u32 s26, s19, 192
    s_cmp_le_i32 s26, 0
    s_cbranch_scc1 Lc_rare_21
    v_lshlrev_b32_sdwa v56, 2, v55 dst_sel:DWORD dst_unused:UNUSED_PAD src0_sel:DWORD src1_sel:BYTE_0
    v_lshlrev_b32_sdwa v57, 2, v55 dst_sel:DWORD dst_unused:UNUSED_PAD src0_sel:DWORD src1_sel:BYTE_1
    v_lshlrev_b32_sdwa v58, 2, v55 dst_sel:DWORD dst_unused:UNUSED_PAD src0_sel:DWORD src1_sel:BYTE_2
    v_lshlrev_b32_sdwa v59, 2, v55 dst_sel:DWORD dst_unused:UNUSED_PAD src0_sel:DWORD src1_sel:BYTE_3
    v_cmpx_gt_i32_e64 s[44:45], s26, v1
    ds_add_rtn_u32 v56, v56, v11 offset:2304
    ds_add_rtn_u32 v57, v57, v11 offset:2304
    ds_add_rtn_u32 v58, v58, v11 offset:2304
    ds_add_rtn_u32 v59, v59, v11 offset:2304
    s_mov_b64 exec, -1
Lc_rare_21:
    s_waitcnt vmcnt(2) lgkmcnt(5)
    s_mov_b64 exec, s[54:55]
    v_bitop3_b32 v3, v3, v92, v93 bitop3:0xfe
    v_bitop3_b32 v3, v3, v94, v95 bitop3:0xfe
    v_pk_mul_f32 v[116:117], v[110:111], v[114:115] op_sel_hi:[1,0]
    v_fma_mix_f32 v118, v110, v114, 0 op_sel_hi:[1,0,0]
    v_fma_mix_f32 v119, v111, v114, 0 op_sel_hi:[1,0,0]
    v_dot2c_f32_bf16 v116, v107, v113
    v_dot2c_f32_bf16 v117, v109, v113
    v_dot2c_f32_bf16 v118, v106, v113
    v_dot2c_f32_bf16 v119, v108, v113
    v_lshlrev_b32 v120, 16, v86
    v_lshlrev_b32 v121, 16, v87
    v_pk_fma_f32 v[92:93], v[86:87], v[116:117], v[6:7] op_sel_hi:[1,1,0]
    v_pk_fma_f32 v[94:95], v[120:121], v[118:119], v[6:7] op_sel_hi:[1,1,0]
    v_lshl_add_u64 v[92:93], v[92:93], 0, v[4:5]
    v_lshl_add_u64 v[94:95], v[94:95], 0, v[4:5]
    ds_add_rtn_u64 v[92:93], v112, v[92:93] offset:34048
    ds_add_rtn_u64 v[94:95], v112, v[94:95] offset:44288
    s_mov_b64 exec, -1
    s_waitcnt lgkmcnt(4)
    v_readlane_b32 s33, v8, 11
    v_and_b32 v82, 0x1ff, v74
    s_add_u32 s4, s32, 1999872
    s_bfm_b64 exec, s33, 0
    s_bitcmp1_b32 s33, 6
    s_cselect_b64 exec, -1, exec
    s_mov_b64 s[50:51], exec
    buffer_load_dwordx2 v[82:83], v82, s[12:15], s4 idxen
    s_mov_b64 exec, -1
    s_cmp_le_u32 s19, 192
    s_cbranch_scc1 Lc_rare_22
    s_waitcnt lgkmcnt(2)
    v_lshlrev_b32_sdwa v122, 2, v56 dst_sel:DWORD dst_unused:UNUSED_PAD src0_sel:DWORD src1_sel:WORD_0
    v_lshlrev_b32_sdwa v123, 2, v57 dst_sel:DWORD dst_unused:UNUSED_PAD src0_sel:DWORD src1_sel:WORD_0
    v_lshlrev_b32_sdwa v124, 2, v58 dst_sel:DWORD dst_unused:UNUSED_PAD src0_sel:DWORD src1_sel:WORD_0
    v_lshlrev_b32_sdwa v125, 2, v59 dst_sel:DWORD dst_unused:UNUSED_PAD src0_sel:DWORD src1_sel:WORD_0
    s_mov_b64 exec, s[44:45]
    v_cmpx_gt_i32_e64 s[80:81], s25, v56
    ds_write_b32 v122, v50
    s_mov_b64 exec, s[44:45]
    v_cmpx_gt_i32_e64 s[82:83], s25, v57
    ds_write_b32 v123, v51
    s_mov_b64 exec, s[44:45]
    v_cmpx_gt_i32_e64 s[84:85], s25, v58
    ds_write_b32 v124, v52
    s_mov_b64 exec, s[44:45]
    v_cmpx_gt_i32_e64 s[86:87], s25, v59
    ds_write_b32 v125, v54
    s_and_b64 s[88:89], s[80:81], s[82:83]
    s_and_b64 exec, exec, s[84:85]
    s_and_b64 s[88:89], s[88:89], exec
    s_cmp_eq_u64 s[88:89], s[44:45]
    s_cbranch_scc1 Lc_no_23
    s_mov_b64 exec, s[44:45]
    s_movk_i32 s90, 573
    s_call_b64 s[88:89], Lc_ovf50
Lc_no_23:
    s_mov_b64 exec, -1
Lc_rare_22:
    s_mov_b64 exec, s[48:49]
    v_lshrrev_b32 v112, 6, v73
    v_cvt_f32_i32 v113, v73
    v_and_b32 v112, 0x3ff8, v112
    v_add_u32 v115, v112, v112
    ds_read_b64 v[110:111], v112 offset:23808
    ds_read_b128 v[106:109], v115 offset:3328
    v_fmaak_f32 v115, v113, v113, 0xddffc004
    v_fmaak_f32 v114, v115, v7, 0xb0001002
    v_mul_f32 v114, v114, v113
    v_cvt_pk_bf16_f32 v113, v113, v115
    s_waitcnt vmcnt(2) lgkmcnt(4)
    s_mov_b64 exec, s[46:47]
    v_bitop3_b32 v3, v3, v88, v89 bitop3:0xfe
    v_bitop3_b32 v3, v3, v90, v91 bitop3:0xfe
    v_pk_mul_f32 v[116:117], v[100:101], v[104:105] op_sel_hi:[1,0]
    v_fma_mix_f32 v118, v100, v104, 0 op_sel_hi:[1,0,0]
    v_fma_mix_f32 v119, v101, v104, 0 op_sel_hi:[1,0,0]
    v_dot2c_f32_bf16 v116, v97, v103
    v_dot2c_f32_bf16 v117, v99, v103
    v_dot2c_f32_bf16 v118, v96, v103
    v_dot2c_f32_bf16 v119, v98, v103
    v_lshlrev_b32 v120, 16, v78
    v_lshlrev_b32 v121, 16, v79
    v_pk_fma_f32 v[88:89], v[78:79], v[116:117], v[6:7] op_sel_hi:[1,1,0]
    v_pk_fma_f32 v[90:91], v[120:121], v[118:119], v[6:7] op_sel_hi:[1,1,0]
    v_lshl_add_u64 v[88:89], v[88:89], 0, v[4:5]
    v_lshl_add_u64 v[90:91], v[90:91], 0, v[4:5]
    ds_add_rtn_u64 v[88:89], v102, v[88:89] offset:34048
    ds_add_rtn_u64 v[90:91], v102, v[90:91] offset:44288
    s_mov_b64 exec, -1
    s_waitcnt lgkmcnt(4)
    s_barrier
    s_setprio 3
    ds_read_b32 v8, v9 offset:2304
    ds_read_b32 v75, v13 offset:0
    ds_read_b32 v76, v13 offset:4160
    s_waitcnt lgkmcnt(1)
    v_ashrrev_i32 v8, 16, v8
    v_med3_i32 v8, v8, 0, 64
    s_nop 0
    v_readlane_b32 s33, v8, 0
    v_and_b32 v84, 0x1ff, v75
    s_add_u32 s4, s32, 2053632
    s_bfm_b64 exec, s33, 0
    s_bitcmp1_b32 s33, 6
    s_cselect_b64 exec, -1, exec
    s_mov_b64 s[52:53], exec
    buffer_load_dwordx2 v[84:85], v84, s[12:15], s4 idxen
    s_mov_b64 exec, s[50:51]
    v_lshrrev_b32 v102, 6, v74
    v_cvt_f32_i32 v103, v74
    v_and_b32 v102, 0x3ff8, v102
    v_add_u32 v105, v102, v102
    ds_read_b64 v[100:101], v102 offset:23808
    ds_read_b128 v[96:99], v105 offset:3328
    v_fmaak_f32 v105, v103, v103, 0xddffc004
    v_fmaak_f32 v104, v105, v7, 0xb0001002
    v_mul_f32 v104, v104, v103
    v_cvt_pk_bf16_f32 v103, v103, v105
    s_waitcnt vmcnt(2)
    s_mov_b64 exec, s[48:49]
    v_bitop3_b32 v3, v3, v92, v93 bitop3:0xfe
    v_bitop3_b32 v3, v3, v94, v95 bitop3:0xfe
    v_pk_mul_f32 v[116:117], v[110:111], v[114:115] op_sel_hi:[1,0]
    v_fma_mix_f32 v118, v110, v114, 0 op_sel_hi:[1,0,0]
    v_fma_mix_f32 v119, v111, v114, 0 op_sel_hi:[1,0,0]
    v_dot2c_f32_bf16 v116, v107, v113
    v_dot2c_f32_bf16 v117, v109, v113
    v_dot2c_f32_bf16 v118, v106, v113
    v_dot2c_f32_bf16 v119, v108, v113
    v_lshlrev_b32 v120, 16, v80
    v_lshlrev_b32 v121, 16, v81
    v_pk_fma_f32 v[92:93], v[80:81], v[116:117], v[6:7] op_sel_hi:[1,1,0]
    v_pk_fma_f32 v[94:95], v[120:121], v[118:119], v[6:7] op_sel_hi:[1,1,0]
    v_lshl_add_u64 v[92:93], v[92:93], 0, v[4:5]
    v_lshl_add_u64 v[94:95], v[94:95], 0, v[4:5]
    ds_add_rtn_u64 v[92:93], v112, v[92:93] offset:34048
    ds_add_rtn_u64 v[94:95], v112, v[94:95] offset:44288
    s_mov_b64 exec, -1
    ds_read_b32 v77, v13 offset:8320
    s_waitcnt lgkmcnt(5)
    v_readlane_b32 s33, v8, 1
    v_and_b32 v86, 0x1ff, v76
    s_add_u32 s4, s32, 2110976
    s_bfm_b64 exec, s33, 0
    s_bitcmp1_b32 s33, 6
    s_cselect_b64 exec, -1, exec
    s_mov_b64 s[54:55], exec
    buffer_load_dwordx2 v[86:87], v86, s[12:15], s4 idxen
    s_mov_b64 exec, s[52:53]
    v_lshrrev_b32 v112, 6, v75
    v_cvt_f32_i32 v113, v75
    v_and_b32 v112, 0x3ff8, v112
    v_add_u32 v115, v112, v112
    ds_read_b64 v[110:111], v112 offset:23808
    ds_read_b128 v[106:109], v115 offset:3328
    v_fmaak_f32 v115, v113, v113, 0xddffc004
    v_fmaak_f32 v114, v115, v7, 0xb0001002
    v_mul_f32 v114, v114, v113
    v_cvt_pk_bf16_f32 v113, v113, v115
    s_waitcnt vmcnt(2) lgkmcnt(5)
    s_mov_b64 exec, s[50:51]
    v_bitop3_b32 v3, v3, v88, v89 bitop3:0xfe
    v_bitop3_b32 v3, v3, v90, v91 bitop3:0xfe
    v_pk_mul_f32 v[116:117], v[100:101], v[104:105] op_sel_hi:[1,0]
    v_fma_mix_f32 v118, v100, v104, 0 op_sel_hi:[1,0,0]
    v_fma_mix_f32 v119, v101, v104, 0 op_sel_hi:[1,0,0]
    v_dot2c_f32_bf16 v116, v97, v103
    v_dot2c_f32_bf16 v117, v99, v103
    v_dot2c_f32_bf16 v118, v96, v103
    v_dot2c_f32_bf16 v119, v98, v103
    v_lshlrev_b32 v120, 16, v82
    v_lshlrev_b32 v121, 16, v83
    v_pk_fma_f32 v[88:89], v[82:83], v[116:117], v[6:7] op_sel_hi:[1,1,0]
    v_pk_fma_f32 v[90:91], v[120:121], v[118:119], v[6:7] op_sel_hi:[1,1,0]
    v_lshl_add_u64 v[88:89], v[88:89], 0, v[4:5]
    v_lshl_add_u64 v[90:91], v[90:91], 0, v[4:5]
    ds_add_rtn_u64 v[88:89], v102, v[88:89] offset:34048
    ds_add_rtn_u64 v[90:91], v102, v[90:91] offset:44288
    s_mov_b64 exec, -1
    ds_read_b32 v72, v13 offset:12480
    s_waitcnt lgkmcnt(5)
    v_readlane_b32 s33, v8, 2
    v_and_b32 v78, 0x1ff, v77
    s_add_u32 s4, s32, 2168320
    s_bfm_b64 exec, s33, 0
    s_bitcmp1_b32 s33, 6
    s_cselect_b64 exec, -1, exec
    s_mov_b64 s[46:47], exec
    buffer_load_dwordx2 v[78:79], v78, s[12:15], s4 idxen
    s_mov_b64 exec, s[54:55]
    v_lshrrev_b32 v102, 6, v76
    v_cvt_f32_i32 v103, v76
    v_and_b32 v102, 0x3ff8, v102
    v_add_u32 v105, v102, v102
    ds_read_b64 v[100:101], v102 offset:23808
    ds_read_b128 v[96:99], v105 offset:3328
    v_fmaak_f32 v105, v103, v103, 0xddffc004
    v_fmaak_f32 v104, v105, v7, 0xb0001002
    v_mul_f32 v104, v104, v103
    v_cvt_pk_bf16_f32 v103, v103, v105
    s_waitcnt vmcnt(2) lgkmcnt(5)
    s_mov_b64 exec, s[52:53]
    v_bitop3_b32 v3, v3, v92, v93 bitop3:0xfe
    v_bitop3_b32 v3, v3, v94, v95 bitop3:0xfe
    v_pk_mul_f32 v[116:117], v[110:111], v[114:115] op_sel_hi:[1,0]
    v_fma_mix_f32 v118, v110, v114, 0 op_sel_hi:[1,0,0]
    v_fma_mix_f32 v119, v111, v114, 0 op_sel_hi:[1,0,0]
    v_dot2c_f32_bf16 v116, v107, v113
    v_dot2c_f32_bf16 v117, v109, v113
    v_dot2c_f32_bf16 v118, v106, v113
    v_dot2c_f32_bf16 v119, v108, v113
    v_lshlrev_b32 v120, 16, v84
    v_lshlrev_b32 v121, 16, v85
    v_pk_fma_f32 v[92:93], v[84:85], v[116:117], v[6:7] op_sel_hi:[1,1,0]
    v_pk_fma_f32 v[94:95], v[120:121], v[118:119], v[6:7] op_sel_hi:[1,1,0]
    v_lshl_add_u64 v[92:93], v[92:93], 0, v[4:5]
    v_lshl_add_u64 v[94:95], v[94:95], 0, v[4:5]
    ds_add_rtn_u64 v[92:93], v112, v[92:93] offset:34048
    ds_add_rtn_u64 v[94:95], v112, v[94:95] offset:44288
    s_mov_b64 exec, -1
    ds_read_b32 v73, v13 offset:16640
    s_waitcnt lgkmcnt(5)
    v_readlane_b32 s33, v8, 3
    v_and_b32 v80, 0x1ff, v72
    s_add_u32 s4, s32, 2225664
    s_bfm_b64 exec, s33, 0
    s_bitcmp1_b32 s33, 6
    s_cselect_b64 exec, -1, exec
    s_mov_b64 s[48:49], exec
    buffer_load_dwordx2 v[80:81], v80, s[12:15], s4 idxen
    s_mov_b64 exec, s[46:47]
    v_lshrrev_b32 v112, 6, v77
    v_cvt_f32_i32 v113, v77
    v_and_b32 v112, 0x3ff8, v112
    v_add_u32 v115, v112, v112
    ds_read_b64 v[110:111], v112 offset:23808
    ds_read_b128 v[106:109], v115 offset:3328
    v_fmaak_f32 v115, v113, v113, 0xddffc004
    v_fmaak_f32 v114, v115, v7, 0xb0001002
    v_mul_f32 v114, v114, v113
    v_cvt_pk_bf16_f32 v113, v113, v115
    s_waitcnt vmcnt(2) lgkmcnt(5)
    s_mov_b64 exec, s[54:55]
    v_bitop3_b32 v3, v3, v88, v89 bitop3:0xfe
    v_bitop3_b32 v3, v3, v90, v91 bitop3:0xfe
    v_pk_mul_f32 v[116:117], v[100:101], v[104:105] op_sel_hi:[1,0]
    v_fma_mix_f32 v118, v100, v104, 0 op_sel_hi:[1,0,0]
    v_fma_mix_f32 v119, v101, v104, 0 op_sel_hi:[1,0,0]
    v_dot2c_f32_bf16 v116, v97, v103
    v_dot2c_f32_bf16 v117, v99, v103
    v_dot2c_f32_bf16 v118, v96, v103
    v_dot2c_f32_bf16 v119, v98, v103
    v_lshlrev_b32 v120, 16, v86
    v_lshlrev_b32 v121, 16, v87
    v_pk_fma_f32 v[88:89], v[86:87], v[116:117], v[6:7] op_sel_hi:[1,1,0]
    v_pk_fma_f32 v[90:91], v[120:121], v[118:119], v[6:7] op_sel_hi:[1,1,0]
    v_lshl_add_u64 v[88:89], v[88:89], 0, v[4:5]
    v_lshl_add_u64 v[90:91], v[90:91], 0, v[4:5]
    ds_add_rtn_u64 v[88:89], v102, v[88:89] offset:34048
    ds_add_rtn_u64 v[90:91], v102, v[90:91] offset:44288
    s_mov_b64 exec, -1
    ds_read_b32 v74, v13 offset:20800
    s_waitcnt lgkmcnt(5)
    v_readlane_b32 s33, v8, 4
    v_and_b32 v82, 0x1ff, v73
    s_add_u32 s4, s32, 2283008
    s_bfm_b64 exec, s33, 0
    s_bitcmp1_b32 s33, 6
    s_cselect_b64 exec, -1, exec
    s_mov_b64 s[50:51], exec
    buffer_load_dwordx2 v[82:83], v82, s[12:15], s4 idxen
    s_mov_b64 exec, -1
    s_setprio 2
    s_mov_b64 exec, s[48:49]
    v_lshrrev_b32 v102, 6, v72
    v_cvt_f32_i32 v103, v72
    v_and_b32 v102, 0x3ff8, v102
    v_add_u32 v105, v102, v102
    ds_read_b64 v[100:101], v102 offset:23808
    ds_read_b128 v[96:99], v105 offset:3328
    v_fmaak_f32 v105, v103, v103, 0xddffc004
    v_fmaak_f32 v104, v105, v7, 0xb0001002
    v_mul_f32 v104, v104, v103
    v_cvt_pk_bf16_f32 v103, v103, v105
    s_waitcnt vmcnt(2) lgkmcnt(5)
    s_mov_b64 exec, s[46:47]
    v_bitop3_b32 v3, v3, v92, v93 bitop3:0xfe
    v_bitop3_b32 v3, v3, v94, v95 bitop3:0xfe
    v_pk_mul_f32 v[116:117], v[110:111], v[114:115] op_sel_hi:[1,0]
    v_fma_mix_f32 v118, v110, v114, 0 op_sel_hi:[1,0,0]
    v_fma_mix_f32 v119, v111, v114, 0 op_sel_hi:[1,0,0]
    v_dot2c_f32_bf16 v116, v107, v113
    v_dot2c_f32_bf16 v117, v109, v113
    v_dot2c_f32_bf16 v118, v106, v113
    v_dot2c_f32_bf16 v119, v108, v113
    v_lshlrev_b32 v120, 16, v78
    v_lshlrev_b32 v121, 16, v79
    v_pk_fma_f32 v[92:93], v[78:79], v[116:117], v[6:7] op_sel_hi:[1,1,0]
    v_pk_fma_f32 v[94:95], v[120:121], v[118:119], v[6:7] op_sel_hi:[1,1,0]
    v_lshl_add_u64 v[92:93], v[92:93], 0, v[4:5]
    v_lshl_add_u64 v[94:95], v[94:95], 0, v[4:5]
    ds_add_rtn_u64 v[92:93], v112, v[92:93] offset:34048
    ds_add_rtn_u64 v[94:95], v112, v[94:95] offset:44288
    s_mov_b64 exec, -1
    v_lshlrev_b32 v42, 3, v0
    v_add_u32 v42, 154368, v42
    ds_read_b64 v[40:41], v42
    ds_read_b32 v43, v2 offset:3076
    s_waitcnt lgkmcnt(6)
    v_readlane_b32 s33, v8, 5
    v_and_b32 v84, 0x1ff, v74
    s_add_u32 s4, s32, 2340352
    s_bfm_b64 exec, s33, 0
    s_bitcmp1_b32 s33, 6
    s_cselect_b64 exec, -1, exec
    s_mov_b64 s[52:53], exec
    buffer_load_dwordx2 v[84:85], v84, s[12:15], s4 idxen
    s_mov_b64 exec, s[50:51]
    v_lshrrev_b32 v112, 6, v73
    v_cvt_f32_i32 v113, v73
    v_and_b32 v112, 0x3ff8, v112
    v_add_u32 v115, v112, v112
    ds_read_b64 v[110:111], v112 offset:23808
    ds_read_b128 v[106:109], v115 offset:3328
    v_fmaak_f32 v115, v113, v113, 0xddffc004
    v_fmaak_f32 v114, v115, v7, 0xb0001002
    v_mul_f32 v114, v114, v113
    v_cvt_pk_bf16_f32 v113, v113, v115
    s_waitcnt vmcnt(2) lgkmcnt(6)
    s_mov_b64 exec, s[48:49]
    v_bitop3_b32 v3, v3, v88, v89 bitop3:0xfe
    v_bitop3_b32 v3, v3, v90, v91 bitop3:0xfe
    v_pk_mul_f32 v[116:117], v[100:101], v[104:105] op_sel_hi:[1,0]
    v_fma_mix_f32 v118, v100, v104, 0 op_sel_hi:[1,0,0]
    v_fma_mix_f32 v119, v101, v104, 0 op_sel_hi:[1,0,0]
    v_dot2c_f32_bf16 v116, v97, v103
    v_dot2c_f32_bf16 v117, v99, v103
    v_dot2c_f32_bf16 v118, v96, v103
    v_dot2c_f32_bf16 v119, v98, v103
    v_lshlrev_b32 v120, 16, v80
    v_lshlrev_b32 v121, 16, v81
    v_pk_fma_f32 v[88:89], v[80:81], v[116:117], v[6:7] op_sel_hi:[1,1,0]
    v_pk_fma_f32 v[90:91], v[120:121], v[118:119], v[6:7] op_sel_hi:[1,1,0]
    v_lshl_add_u64 v[88:89], v[88:89], 0, v[4:5]
    v_lshl_add_u64 v[90:91], v[90:91], 0, v[4:5]
    ds_add_rtn_u64 v[88:89], v102, v[88:89] offset:34048
    ds_add_rtn_u64 v[90:91], v102, v[90:91] offset:44288
    s_mov_b64 exec, -1
    ds_read_b32 v76, v13 offset:24960
    s_waitcnt lgkmcnt(5)
    v_mul_u32_u24 v87, 448, v41
    v_and_b32 v86, 0x1ff, v40
    v_add_u32 v86, v86, v87
    v_readfirstlane_b32 s4, v43
    s_cmp_gt_u32 s4, 162560
    s_cselect_b32 s9, 1, s9
    v_cmpx_gt_u32_e64 s[54:55], s4, v42
    buffer_load_dwordx2 v[86:87], v86, s[12:15], 0 idxen
    s_mov_b64 exec, s[52:53]
    v_lshrrev_b32 v102, 6, v74
    v_cvt_f32_i32 v103, v74
    v_and_b32 v102, 0x3ff8, v102
    v_add_u32 v105, v102, v102
    ds_read_b64 v[100:101], v102 offset:23808
    ds_read_b128 v[96:99], v105 offset:3328
    v_fmaak_f32 v105, v103, v103, 0xddffc004
    v_fmaak_f32 v104, v105, v7, 0xb0001002
    v_mul_f32 v104, v104, v103
    v_cvt_pk_bf16_f32 v103, v103, v105
    s_waitcnt vmcnt(2) lgkmcnt(5)
    s_mov_b64 exec, s[50:51]
    v_bitop3_b32 v3, v3, v92, v93 bitop3:0xfe
    v_bitop3_b32 v3, v3, v94, v95 bitop3:0xfe
    v_pk_mul_f32 v[116:117], v[110:111], v[114:115] op_sel_hi:[1,0]
    v_fma_mix_f32 v118, v110, v114, 0 op_sel_hi:[1,0,0]
    v_fma_mix_f32 v119, v111, v114, 0 op_sel_hi:[1,0,0]
    v_dot2c_f32_bf16 v116, v107, v113
    v_dot2c_f32_bf16 v117, v109, v113
    v_dot2c_f32_bf16 v118, v106, v113
    v_dot2c_f32_bf16 v119, v108, v113
    v_lshlrev_b32 v120, 16, v82
    v_lshlrev_b32 v121, 16, v83
    v_pk_fma_f32 v[92:93], v[82:83], v[116:117], v[6:7] op_sel_hi:[1,1,0]
    v_pk_fma_f32 v[94:95], v[120:121], v[118:119], v[6:7] op_sel_hi:[1,1,0]
    v_lshl_add_u64 v[92:93], v[92:93], 0, v[4:5]
    v_lshl_add_u64 v[94:95], v[94:95], 0, v[4:5]
    ds_add_rtn_u64 v[92:93], v112, v[92:93] offset:34048
    ds_add_rtn_u64 v[94:95], v112, v[94:95] offset:44288
    s_mov_b64 exec, -1
    ds_read_b32 v77, v13 offset:29120
    s_waitcnt lgkmcnt(5)
    v_readlane_b32 s33, v8, 6
    v_and_b32 v78, 0x1ff, v76
    s_add_u32 s4, s32, 2397696
    s_bfm_b64 exec, s33, 0
    s_bitcmp1_b32 s33, 6
    s_cselect_b64 exec, -1, exec
    s_mov_b64 s[46:47], exec
    buffer_load_dwordx2 v[78:79], v78, s[12:15], s4 idxen
    s_mov_b64 exec, s[54:55]
    v_lshrrev_b32 v112, 6, v40
    v_cvt_f32_i32 v113, v40
    v_and_b32 v112, 0x3ff8, v112
    v_add_u32 v115, v112, v112
    ds_read_b64 v[110:111], v112 offset:23808
    ds_read_b128 v[106:109], v115 offset:3328
    v_fmaak_f32 v115, v113, v113, 0xddffc004
    v_fmaak_f32 v114, v115, v7, 0xb0001002
    v_mul_f32 v114, v114, v113
    v_cvt_pk_bf16_f32 v113, v113, v115
    s_waitcnt vmcnt(2) lgkmcnt(5)
    s_mov_b64 exec, s[52:53]
    v_bitop3_b32 v3, v3, v88, v89 bitop3:0xfe
    v_bitop3_b32 v3, v3, v90, v91 bitop3:0xfe
    v_pk_mul_f32 v[116:117], v[100:101], v[104:105] op_sel_hi:[1,0]
    v_fma_mix_f32 v118, v100, v104, 0 op_sel_hi:[1,0,0]
    v_fma_mix_f32 v119, v101, v104, 0 op_sel_hi:[1,0,0]
    v_dot2c_f32_bf16 v116, v97, v103
    v_dot2c_f32_bf16 v117, v99, v103
    v_dot2c_f32_bf16 v118, v96, v103
    v_dot2c_f32_bf16 v119, v98, v103
    v_lshlrev_b32 v120, 16, v84
    v_lshlrev_b32 v121, 16, v85
    v_pk_fma_f32 v[88:89], v[84:85], v[116:117], v[6:7] op_sel_hi:[1,1,0]
    v_pk_fma_f32 v[90:91], v[120:121], v[118:119], v[6:7] op_sel_hi:[1,1,0]
    v_lshl_add_u64 v[88:89], v[88:89], 0, v[4:5]
    v_lshl_add_u64 v[90:91], v[90:91], 0, v[4:5]
    ds_add_rtn_u64 v[88:89], v102, v[88:89] offset:34048
    ds_add_rtn_u64 v[90:91], v102, v[90:91] offset:44288
    s_mov_b64 exec, -1
    ds_read_b32 v72, v13 offset:33280
    s_waitcnt lgkmcnt(5)
    v_readlane_b32 s33, v8, 7
    v_and_b32 v80, 0x1ff, v77
    s_add_u32 s4, s32, 2455040
    s_bfm_b64 exec, s33, 0
    s_bitcmp1_b32 s33, 6
    s_cselect_b64 exec, -1, exec
    s_mov_b64 s[48:49], exec
    buffer_load_dwordx2 v[80:81], v80, s[12:15], s4 idxen
    s_mov_b64 exec, -1
    s_setprio 1
    s_mov_b64 exec, s[46:47]
    v_lshrrev_b32 v102, 6, v76
    v_cvt_f32_i32 v103, v76
    v_and_b32 v102, 0x3ff8, v102
    v_add_u32 v105, v102, v102
    ds_read_b64 v[100:101], v102 offset:23808
    ds_read_b128 v[96:99], v105 offset:3328
    v_fmaak_f32 v105, v103, v103, 0xddffc004
    v_fmaak_f32 v104, v105, v7, 0xb0001002
    v_mul_f32 v104, v104, v103
    v_cvt_pk_bf16_f32 v103, v103, v105
    s_waitcnt vmcnt(2) lgkmcnt(5)
    s_mov_b64 exec, s[54:55]
    v_bitop3_b32 v3, v3, v92, v93 bitop3:0xfe
    v_bitop3_b32 v3, v3, v94, v95 bitop3:0xfe
    v_pk_mul_f32 v[116:117], v[110:111], v[114:115] op_sel_hi:[1,0]
    v_fma_mix_f32 v118, v110, v114, 0 op_sel_hi:[1,0,0]
    v_fma_mix_f32 v119, v111, v114, 0 op_sel_hi:[1,0,0]
    v_dot2c_f32_bf16 v116, v107, v113
    v_dot2c_f32_bf16 v117, v109, v113
    v_dot2c_f32_bf16 v118, v106, v113
    v_dot2c_f32_bf16 v119, v108, v113
    v_lshlrev_b32 v120, 16, v86
    v_lshlrev_b32 v121, 16, v87
    v_pk_fma_f32 v[92:93], v[86:87], v[116:117], v[6:7] op_sel_hi:[1,1,0]
    v_pk_fma_f32 v[94:95], v[120:121], v[118:119], v[6:7] op_sel_hi:[1,1,0]
    v_lshl_add_u64 v[92:93], v[92:93], 0, v[4:5]
    v_lshl_add_u64 v[94:95], v[94:95], 0, v[4:5]
    ds_add_rtn_u64 v[92:93], v112, v[92:93] offset:34048
    ds_add_rtn_u64 v[94:95], v112, v[94:95] offset:44288
    s_mov_b64 exec, -1
    ds_read_b32 v73, v13 offset:37440
    s_waitcnt lgkmcnt(5)
    v_readlane_b32 s33, v8, 8
    v_and_b32 v82, 0x1ff, v72
    s_add_u32 s4, s32, 2512384
    s_bfm_b64 exec, s33, 0
    s_bitcmp1_b32 s33, 6
    s_cselect_b64 exec, -1, exec
    s_mov_b64 s[50:51], exec
    buffer_load_dwordx2 v[82:83], v82, s[12:15], s4 idxen
    s_mov_b64 exec, s[48:49]
    v_lshrrev_b32 v112, 6, v77
    v_cvt_f32_i32 v113, v77
    v_and_b32 v112, 0x3ff8, v112
    v_add_u32 v115, v112, v112
    ds_read_b64 v[110:111], v112 offset:23808
    ds_read_b128 v[106:109], v115 offset:3328
    v_fmaak_f32 v115, v113, v113, 0xddffc004
    v_fmaak_f32 v114, v115, v7, 0xb0001002
    v_mul_f32 v114, v114, v113
    v_cvt_pk_bf16_f32 v113, v113, v115
    s_waitcnt vmcnt(2) lgkmcnt(5)
    s_mov_b64 exec, s[46:47]
    v_bitop3_b32 v3, v3, v88, v89 bitop3:0xfe
    v_bitop3_b32 v3, v3, v90, v91 bitop3:0xfe
    v_pk_mul_f32 v[116:117], v[100:101], v[104:105] op_sel_hi:[1,0]
    v_fma_mix_f32 v118, v100, v104, 0 op_sel_hi:[1,0,0]
    v_fma_mix_f32 v119, v101, v104, 0 op_sel_hi:[1,0,0]
    v_dot2c_f32_bf16 v116, v97, v103
    v_dot2c_f32_bf16 v117, v99, v103
    v_dot2c_f32_bf16 v118, v96, v103
    v_dot2c_f32_bf16 v119, v98, v103
    v_lshlrev_b32 v120, 16, v78
    v_lshlrev_b32 v121, 16, v79
    v_pk_fma_f32 v[88:89], v[78:79], v[116:117], v[6:7] op_sel_hi:[1,1,0]
    v_pk_fma_f32 v[90:91], v[120:121], v[118:119], v[6:7] op_sel_hi:[1,1,0]
    v_lshl_add_u64 v[88:89], v[88:89], 0, v[4:5]
    v_lshl_add_u64 v[90:91], v[90:91], 0, v[4:5]
    ds_add_rtn_u64 v[88:89], v102, v[88:89] offset:34048
    ds_add_rtn_u64 v[90:91], v102, v[90:91] offset:44288
    s_mov_b64 exec, -1
    ds_read_b32 v74, v13 offset:41600
    s_waitcnt lgkmcnt(5)
    v_readlane_b32 s33, v8, 9
    v_and_b32 v84, 0x1ff, v73
    s_add_u32 s4, s32, 2569728
    s_bfm_b64 exec, s33, 0
    s_bitcmp1_b32 s33, 6
    s_cselect_b64 exec, -1, exec
    s_mov_b64 s[52:53], exec
    buffer_load_dwordx2 v[84:85], v84, s[12:15], s4 idxen
    s_mov_b64 exec, s[50:51]
    v_lshrrev_b32 v102, 6, v72
    v_cvt_f32_i32 v103, v72
    v_and_b32 v102, 0x3ff8, v102
    v_add_u32 v105, v102, v102
    ds_read_b64 v[100:101], v102 offset:23808
    ds_read_b128 v[96:99], v105 offset:3328
    v_fmaak_f32 v105, v103, v103, 0xddffc004
    v_fmaak_f32 v104, v105, v7, 0xb0001002
    v_mul_f32 v104, v104, v103
    v_cvt_pk_bf16_f32 v103, v103, v105
    s_waitcnt vmcnt(2) lgkmcnt(5)
    s_mov_b64 exec, s[48:49]
    v_bitop3_b32 v3, v3, v92, v93 bitop3:0xfe
    v_bitop3_b32 v3, v3, v94, v95 bitop3:0xfe
    v_pk_mul_f32 v[116:117], v[110:111], v[114:115] op_sel_hi:[1,0]
    v_fma_mix_f32 v118, v110, v114, 0 op_sel_hi:[1,0,0]
    v_fma_mix_f32 v119, v111, v114, 0 op_sel_hi:[1,0,0]
    v_dot2c_f32_bf16 v116, v107, v113
    v_dot2c_f32_bf16 v117, v109, v113
    v_dot2c_f32_bf16 v118, v106, v113
    v_dot2c_f32_bf16 v119, v108, v113
    v_lshlrev_b32 v120, 16, v80
    v_lshlrev_b32 v121, 16, v81
    v_pk_fma_f32 v[92:93], v[80:81], v[116:117], v[6:7] op_sel_hi:[1,1,0]
    v_pk_fma_f32 v[94:95], v[120:121], v[118:119], v[6:7] op_sel_hi:[1,1,0]
    v_lshl_add_u64 v[92:93], v[92:93], 0, v[4:5]
    v_lshl_add_u64 v[94:95], v[94:95], 0, v[4:5]
    ds_add_rtn_u64 v[92:93], v112, v[92:93] offset:34048
    ds_add_rtn_u64 v[94:95], v112, v[94:95] offset:44288
    s_mov_b64 exec, -1
    ds_read_b32 v75, v13 offset:45760
    s_waitcnt lgkmcnt(5)
    v_readlane_b32 s33, v8, 10
    v_and_b32 v86, 0x1ff, v74
    s_add_u32 s4, s32, 2627072
    s_bfm_b64 exec, s33, 0
    s_bitcmp1_b32 s33, 6
    s_cselect_b64 exec, -1, exec
    s_mov_b64 s[54:55], exec
    buffer_load_dwordx2 v[86:87], v86, s[12:15], s4 idxen
    s_mov_b64 exec, s[52:53]
    v_lshrrev_b32 v112, 6, v73
    v_cvt_f32_i32 v113, v73
    v_and_b32 v112, 0x3ff8, v112
    v_add_u32 v115, v112, v112
    ds_read_b64 v[110:111], v112 offset:23808
    ds_read_b128 v[106:109], v115 offset:3328
    v_fmaak_f32 v115, v113, v113, 0xddffc004
    v_fmaak_f32 v114, v115, v7, 0xb0001002
    v_mul_f32 v114, v114, v113
    v_cvt_pk_bf16_f32 v113, v113, v115
    s_waitcnt vmcnt(2) lgkmcnt(5)
    s_mov_b64 exec, s[50:51]
    v_bitop3_b32 v3, v3, v88, v89 bitop3:0xfe
    v_bitop3_b32 v3, v3, v90, v91 bitop3:0xfe
    v_pk_mul_f32 v[116:117], v[100:101], v[104:105] op_sel_hi:[1,0]
    v_fma_mix_f32 v118, v100, v104, 0 op_sel_hi:[1,0,0]
    v_fma_mix_f32 v119, v101, v104, 0 op_sel_hi:[1,0,0]
    v_dot2c_f32_bf16 v116, v97, v103
    v_dot2c_f32_bf16 v117, v99, v103
    v_dot2c_f32_bf16 v118, v96, v103
    v_dot2c_f32_bf16 v119, v98, v103
    v_lshlrev_b32 v120, 16, v82
    v_lshlrev_b32 v121, 16, v83
    v_pk_fma_f32 v[88:89], v[82:83], v[116:117], v[6:7] op_sel_hi:[1,1,0]
    v_pk_fma_f32 v[90:91], v[120:121], v[118:119], v[6:7] op_sel_hi:[1,1,0]
    v_lshl_add_u64 v[88:89], v[88:89], 0, v[4:5]
    v_lshl_add_u64 v[90:91], v[90:91], 0, v[4:5]
    ds_add_rtn_u64 v[88:89], v102, v[88:89] offset:34048
    ds_add_rtn_u64 v[90:91], v102, v[90:91] offset:44288
    s_mov_b64 exec, -1
    s_waitcnt lgkmcnt(4)
    v_readlane_b32 s33, v8, 11
    v_and_b32 v78, 0x1ff, v75
    s_add_u32 s4, s32, 2684416
    s_bfm_b64 exec, s33, 0
    s_bitcmp1_b32 s33, 6
    s_cselect_b64 exec, -1, exec
    s_mov_b64 s[46:47], exec
    buffer_load_dwordx2 v[78:79], v78, s[12:15], s4 idxen
    s_mov_b64 exec, -1
    s_setprio 0
    s_mov_b64 exec, s[54:55]
    v_lshrrev_b32 v102, 6, v74
    v_cvt_f32_i32 v103, v74
    v_and_b32 v102, 0x3ff8, v102
    v_add_u32 v105, v102, v102
    ds_read_b64 v[100:101], v102 offset:23808
    ds_read_b128 v[96:99], v105 offset:3328
    v_fmaak_f32 v105, v103, v103, 0xddffc004
    v_fmaak_f32 v104, v105, v7, 0xb0001002
    v_mul_f32 v104, v104, v103
    v_cvt_pk_bf16_f32 v103, v103, v105
    s_waitcnt vmcnt(2) lgkmcnt(4)
    s_mov_b64 exec, s[52:53]
    v_bitop3_b32 v3, v3, v92, v93 bitop3:0xfe
    v_bitop3_b32 v3, v3, v94, v95 bitop3:0xfe
    v_pk_mul_f32 v[116:117], v[110:111], v[114:115] op_sel_hi:[1,0]
    v_fma_mix_f32 v118, v110, v114, 0 op_sel_hi:[1,0,0]
    v_fma_mix_f32 v119, v111, v114, 0 op_sel_hi:[1,0,0]
    v_dot2c_f32_bf16 v116, v107, v113
    v_dot2c_f32_bf16 v117, v109, v113
    v_dot2c_f32_bf16 v118, v106, v113
    v_dot2c_f32_bf16 v119, v108, v113
    v_lshlrev_b32 v120, 16, v84
    v_lshlrev_b32 v121, 16, v85
    v_pk_fma_f32 v[92:93], v[84:85], v[116:117], v[6:7] op_sel_hi:[1,1,0]
    v_pk_fma_f32 v[94:95], v[120:121], v[118:119], v[6:7] op_sel_hi:[1,1,0]
    v_lshl_add_u64 v[92:93], v[92:93], 0, v[4:5]
    v_lshl_add_u64 v[94:95], v[94:95], 0, v[4:5]
    ds_add_rtn_u64 v[92:93], v112, v[92:93] offset:34048
    ds_add_rtn_u64 v[94:95], v112, v[94:95] offset:44288
    s_mov_b64 exec, s[46:47]
    v_lshrrev_b32 v112, 6, v75
    v_cvt_f32_i32 v113, v75
    v_and_b32 v112, 0x3ff8, v112
    v_add_u32 v115, v112, v112
    ds_read_b64 v[110:111], v112 offset:23808
    ds_read_b128 v[106:109], v115 offset:3328
    v_fmaak_f32 v115, v113, v113, 0xddffc004
    v_fmaak_f32 v114, v115, v7, 0xb0001002
    v_mul_f32 v114, v114, v113
    v_cvt_pk_bf16_f32 v113, v113, v115
    s_waitcnt vmcnt(1) lgkmcnt(4)
    s_mov_b64 exec, s[54:55]
    v_bitop3_b32 v3, v3, v88, v89 bitop3:0xfe
    v_bitop3_b32 v3, v3, v90, v91 bitop3:0xfe
    v_pk_mul_f32 v[116:117], v[100:101], v[104:105] op_sel_hi:[1,0]
    v_fma_mix_f32 v118, v100, v104, 0 op_sel_hi:[1,0,0]
    v_fma_mix_f32 v119, v101, v104, 0 op_sel_hi:[1,0,0]
    v_dot2c_f32_bf16 v116, v97, v103
    v_dot2c_f32_bf16 v117, v99, v103
    v_dot2c_f32_bf16 v118, v96, v103
    v_dot2c_f32_bf16 v119, v98, v103
    v_lshlrev_b32 v120, 16, v86
    v_lshlrev_b32 v121, 16, v87
    v_pk_fma_f32 v[88:89], v[86:87], v[116:117], v[6:7] op_sel_hi:[1,1,0]
    v_pk_fma_f32 v[90:91], v[120:121], v[118:119], v[6:7] op_sel_hi:[1,1,0]
    v_lshl_add_u64 v[88:89], v[88:89], 0, v[4:5]
    v_lshl_add_u64 v[90:91], v[90:91], 0, v[4:5]
    ds_add_rtn_u64 v[88:89], v102, v[88:89] offset:34048
    ds_add_rtn_u64 v[90:91], v102, v[90:91] offset:44288
    s_mov_b64 exec, -1
    s_waitcnt vmcnt(0) lgkmcnt(2)
    s_mov_b64 exec, s[46:47]
    v_bitop3_b32 v3, v3, v92, v93 bitop3:0xfe
    v_bitop3_b32 v3, v3, v94, v95 bitop3:0xfe
    v_pk_mul_f32 v[116:117], v[110:111], v[114:115] op_sel_hi:[1,0]
    v_fma_mix_f32 v118, v110, v114, 0 op_sel_hi:[1,0,0]
    v_fma_mix_f32 v119, v111, v114, 0 op_sel_hi:[1,0,0]
    v_dot2c_f32_bf16 v116, v107, v113
    v_dot2c_f32_bf16 v117, v109, v113
    v_dot2c_f32_bf16 v118, v106, v113
    v_dot2c_f32_bf16 v119, v108, v113
    v_lshlrev_b32 v120, 16, v78
    v_lshlrev_b32 v121, 16, v79
    v_pk_fma_f32 v[92:93], v[78:79], v[116:117], v[6:7] op_sel_hi:[1,1,0]
    v_pk_fma_f32 v[94:95], v[120:121], v[118:119], v[6:7] op_sel_hi:[1,1,0]
    v_lshl_add_u64 v[92:93], v[92:93], 0, v[4:5]
    v_lshl_add_u64 v[94:95], v[94:95], 0, v[4:5]
    ds_add_rtn_u64 v[92:93], v112, v[92:93] offset:34048
    ds_add_rtn_u64 v[94:95], v112, v[94:95] offset:44288
    s_mov_b64 exec, -1
    s_waitcnt vmcnt(0)
    v_lshlrev_b32 v60, 16, v30
    v_and_b32 v61, 0xffff0000, v30
    v_lshlrev_b32 v62, 16, v31
    v_and_b32 v63, 0xffff0000, v31
    v_lshlrev_b32 v64, 16, v14
    v_and_b32 v65, 0xffff0000, v14
    v_lshlrev_b32 v66, 16, v15
    v_and_b32 v67, 0xffff0000, v15
    v_lshlrev_b32 v68, 16, v34
    v_and_b32 v69, 0xffff0000, v34
    v_lshlrev_b32 v70, 16, v35
    v_and_b32 v71, 0xffff0000, v35
    v_lshlrev_b32 v72, 16, v16
    v_and_b32 v73, 0xffff0000, v16
    v_lshlrev_b32 v74, 16, v17
    v_and_b32 v75, 0xffff0000, v17
    s_pack_ll_b32_b16 s92, s72, s74
    s_pack_hh_b32_b16 s93, s72, s74
    s_pack_ll_b32_b16 s94, s73, s75
    s_pack_hh_b32_b16 s95, s73, s75
    s_pack_ll_b32_b16 s96, s76, s78
    s_pack_hh_b32_b16 s97, s76, s78
    s_pack_ll_b32_b16 s98, s77, s79
    s_pack_hh_b32_b16 s99, s77, s79
    v_lshlrev_b32 v123, 3, v0
    s_waitcnt lgkmcnt(0)
    v_bitop3_b32 v3, v3, v88, v89 bitop3:0xfe
    v_bitop3_b32 v3, v3, v90, v91 bitop3:0xfe
    v_bitop3_b32 v3, v3, v92, v93 bitop3:0xfe
    v_bitop3_b32 v3, v3, v94, v95 bitop3:0xfe
    v_cmp_gt_i32 vcc, 0, v3
    s_cmp_lg_u64 vcc, 0
    s_cselect_b32 s4, 2, 0
    s_or_b32 s4, s4, s9
    s_cbranch_scc0 Lc_noflag
    v_mov_b32 v122, s4
    ds_or_b32 v2, v122 offset:3080
    s_waitcnt lgkmcnt(0)
Lc_noflag:
    s_barrier
    ds_read_b32 v122, v2 offset:3080
    ds_read_b64 v[18:19], v123 offset:34048
    ds_read_b64 v[20:21], v123 offset:44288
    ds_read_b64 v[22:23], v123 offset:42240
    ds_read_b64 v[24:25], v123 offset:52480
    s_waitcnt lgkmcnt(2)
    v_readfirstlane_b32 s7, v122
    v_subrev_u32 v18, 0x40000000, v18
    v_subrev_u32 v19, 0x40000000, v19
    v_subrev_u32 v20, 0x40000000, v20
    v_subrev_u32 v21, 0x40000000, v21
    v_cvt_f32_i32 v18, v18
    v_cvt_f32_i32 v19, v19
    v_cvt_f32_i32 v20, v20
    v_cvt_f32_i32 v21, v21
    v_ldexp_f32 v18, v18, s27
    v_ldexp_f32 v19, v19, s27
    v_ldexp_f32 v20, v20, s27
    v_ldexp_f32 v21, v21, s27
    s_cmp_lg_u32 s7, 0
    s_cbranch_scc1 Lc_slow
    v_cvt_pk_bf16_f32 v18, v20, v18
    v_cvt_pk_bf16_f32 v19, v21, v19
    v_dot2_f32_bf16 v96, v18, s92, 0
    v_dot2_f32_bf16 v97, v18, s93, 0
    v_dot2_f32_bf16 v98, v18, s94, 0
    v_dot2_f32_bf16 v99, v18, s95, 0
    v_dot2_f32_bf16 v96, v19, s96, v96
    v_dot2_f32_bf16 v97, v19, s97, v97
    v_dot2_f32_bf16 v98, v19, s98, v98
    v_dot2_f32_bf16 v99, v19, s99, v99
    v_cvt_pk_bf16_f32 v96, 0, v96
    v_cvt_pk_bf16_f32 v97, 0, v97
    v_cvt_pk_bf16_f32 v98, 0, v98
    v_cvt_pk_bf16_f32 v99, 0, v99
    v_mul_f32 v96, v96, v64
    v_mul_f32 v97, v97, v65
    v_mul_f32 v98, v98, v66
    v_mul_f32 v99, v99, v67
    v_cvt_pk_bf16_f32 v96, 0, v96
    v_cvt_pk_bf16_f32 v97, 0, v97
    v_cvt_pk_bf16_f32 v98, 0, v98
    v_cvt_pk_bf16_f32 v99, 0, v99
    v_add_f32 v96, v96, v60
    v_add_f32 v97, v97, v61
    v_add_f32 v98, v98, v62
    v_add_f32 v99, v99, v63
    v_cvt_pk_bf16_f32 v30, v96, v97
    v_cvt_pk_bf16_f32 v31, v98, v99
    buffer_store_dwordx2 v[30:31], v32, s[28:31], 0 offen sc1
    s_cmp_ge_u32 s6, 4
    s_cbranch_scc1 Lc_done
    s_waitcnt lgkmcnt(0)
    v_subrev_u32 v22, 0x40000000, v22
    v_subrev_u32 v23, 0x40000000, v23
    v_subrev_u32 v24, 0x40000000, v24
    v_subrev_u32 v25, 0x40000000, v25
    v_cvt_f32_i32 v22, v22
    v_cvt_f32_i32 v23, v23
    v_cvt_f32_i32 v24, v24
    v_cvt_f32_i32 v25, v25
    v_ldexp_f32 v22, v22, s27
    v_ldexp_f32 v23, v23, s27
    v_ldexp_f32 v24, v24, s27
    v_ldexp_f32 v25, v25, s27
    v_cvt_pk_bf16_f32 v22, v24, v22
    v_cvt_pk_bf16_f32 v23, v25, v23
    v_dot2_f32_bf16 v96, v22, s92, 0
    v_dot2_f32_bf16 v97, v22, s93, 0
    v_dot2_f32_bf16 v98, v22, s94, 0
    v_dot2_f32_bf16 v99, v22, s95, 0
    v_dot2_f32_bf16 v96, v23, s96, v96
    v_dot2_f32_bf16 v97, v23, s97, v97
    v_dot2_f32_bf16 v98, v23, s98, v98
    v_dot2_f32_bf16 v99, v23, s99, v99
    v_cvt_pk_bf16_f32 v96, 0, v96
    v_cvt_pk_bf16_f32 v97, 0, v97
    v_cvt_pk_bf16_f32 v98, 0, v98
    v_cvt_pk_bf16_f32 v99, 0, v99
    v_mul_f32 v96, v96, v72
    v_mul_f32 v97, v97, v73
    v_mul_f32 v98, v98, v74
    v_mul_f32 v99, v99, v75
    v_cvt_pk_bf16_f32 v96, 0, v96
    v_cvt_pk_bf16_f32 v97, 0, v97
    v_cvt_pk_bf16_f32 v98, 0, v98
    v_cvt_pk_bf16_f32 v99, 0, v99
    v_add_f32 v96, v96, v68
    v_add_f32 v97, v97, v69
    v_add_f32 v98, v98, v70
    v_add_f32 v99, v99, v71
    v_cvt_pk_bf16_f32 v34, v96, v97
    v_cvt_pk_bf16_f32 v35, v98, v99
    buffer_store_dwordx2 v[34:35], v36, s[28:31], 0 offen sc1
Lc_done:
Lc_end:
    s_endpgm
Lc_ovf40:
    v_mov_b32 v43, 8
    v_add_u32_sdwa v122, s90, v45 dst_sel:DWORD dst_unused:UNUSED_PAD src0_sel:DWORD src1_sel:BYTE_0
    v_add_u32_sdwa v123, s90, v45 dst_sel:DWORD dst_unused:UNUSED_PAD src0_sel:DWORD src1_sel:BYTE_1
    v_add_u32_sdwa v124, s90, v45 dst_sel:DWORD dst_unused:UNUSED_PAD src0_sel:DWORD src1_sel:BYTE_2
    v_add_u32_sdwa v125, s90, v45 dst_sel:DWORD dst_unused:UNUSED_PAD src0_sel:DWORD src1_sel:BYTE_3
    s_andn2_b64 s[80:81], exec, s[80:81]
    s_andn2_b64 s[82:83], exec, s[82:83]
    s_andn2_b64 s[84:85], exec, s[84:85]
    s_andn2_b64 s[86:87], exec, s[86:87]
    s_mov_b32 s4, 162560
    s_mov_b64 exec, s[80:81]
    ds_add_rtn_u32 v46, v2, v43 offset:3076
    s_mov_b64 exec, s[82:83]
    ds_add_rtn_u32 v47, v2, v43 offset:3076
    s_mov_b64 exec, s[84:85]
    ds_add_rtn_u32 v48, v2, v43 offset:3076
    s_mov_b64 exec, s[86:87]
    ds_add_rtn_u32 v49, v2, v43 offset:3076
    s_waitcnt lgkmcnt(0)
    s_mov_b64 exec, s[80:81]
    v_cmpx_gt_u32 vcc, s4, v46
    ds_write2_b32 v46, v40, v122 offset1:1
    s_mov_b64 exec, s[82:83]
    v_cmpx_gt_u32 vcc, s4, v47
    ds_write2_b32 v47, v41, v123 offset1:1
    s_mov_b64 exec, s[84:85]
    v_cmpx_gt_u32 vcc, s4, v48
    ds_write2_b32 v48, v42, v124 offset1:1
    s_mov_b64 exec, s[86:87]
    v_cmpx_gt_u32 vcc, s4, v49
    ds_write2_b32 v49, v44, v125 offset1:1
    s_nop 2
    s_setpc_b64 s[88:89]
Lc_ovf50:
    v_mov_b32 v53, 8
    v_add_u32_sdwa v122, s90, v55 dst_sel:DWORD dst_unused:UNUSED_PAD src0_sel:DWORD src1_sel:BYTE_0
    v_add_u32_sdwa v123, s90, v55 dst_sel:DWORD dst_unused:UNUSED_PAD src0_sel:DWORD src1_sel:BYTE_1
    v_add_u32_sdwa v124, s90, v55 dst_sel:DWORD dst_unused:UNUSED_PAD src0_sel:DWORD src1_sel:BYTE_2
    v_add_u32_sdwa v125, s90, v55 dst_sel:DWORD dst_unused:UNUSED_PAD src0_sel:DWORD src1_sel:BYTE_3
    s_andn2_b64 s[80:81], exec, s[80:81]
    s_andn2_b64 s[82:83], exec, s[82:83]
    s_andn2_b64 s[84:85], exec, s[84:85]
    s_andn2_b64 s[86:87], exec, s[86:87]
    s_mov_b32 s4, 162560
    s_mov_b64 exec, s[80:81]
    ds_add_rtn_u32 v56, v2, v53 offset:3076
    s_mov_b64 exec, s[82:83]
    ds_add_rtn_u32 v57, v2, v53 offset:3076
    s_mov_b64 exec, s[84:85]
    ds_add_rtn_u32 v58, v2, v53 offset:3076
    s_mov_b64 exec, s[86:87]
    ds_add_rtn_u32 v59, v2, v53 offset:3076
    s_waitcnt lgkmcnt(0)
    s_mov_b64 exec, s[80:81]
    v_cmpx_gt_u32 vcc, s4, v56
    ds_write2_b32 v56, v50, v122 offset1:1
    s_mov_b64 exec, s[82:83]
    v_cmpx_gt_u32 vcc, s4, v57
    ds_write2_b32 v57, v51, v123 offset1:1
    s_mov_b64 exec, s[84:85]
    v_cmpx_gt_u32 vcc, s4, v58
    ds_write2_b32 v58, v52, v124 offset1:1
    s_mov_b64 exec, s[86:87]
    v_cmpx_gt_u32 vcc, s4, v59
    ds_write2_b32 v59, v54, v125 offset1:1
    s_nop 2
    s_setpc_b64 s[88:89]
Lc_ovf60:
    v_mov_b32 v63, 8
    v_add_u32_sdwa v122, s90, v65 dst_sel:DWORD dst_unused:UNUSED_PAD src0_sel:DWORD src1_sel:BYTE_0
    v_add_u32_sdwa v123, s90, v65 dst_sel:DWORD dst_unused:UNUSED_PAD src0_sel:DWORD src1_sel:BYTE_1
    v_add_u32_sdwa v124, s90, v65 dst_sel:DWORD dst_unused:UNUSED_PAD src0_sel:DWORD src1_sel:BYTE_2
    v_add_u32_sdwa v125, s90, v65 dst_sel:DWORD dst_unused:UNUSED_PAD src0_sel:DWORD src1_sel:BYTE_3
    s_andn2_b64 s[80:81], exec, s[80:81]
    s_andn2_b64 s[82:83], exec, s[82:83]
    s_andn2_b64 s[84:85], exec, s[84:85]
    s_andn2_b64 s[86:87], exec, s[86:87]
    s_mov_b32 s4, 162560
    s_mov_b64 exec, s[80:81]
    ds_add_rtn_u32 v66, v2, v63 offset:3076
    s_mov_b64 exec, s[82:83]
    ds_add_rtn_u32 v67, v2, v63 offset:3076
    s_mov_b64 exec, s[84:85]
    ds_add_rtn_u32 v68, v2, v63 offset:3076
    s_mov_b64 exec, s[86:87]
    ds_add_rtn_u32 v69, v2, v63 offset:3076
    s_waitcnt lgkmcnt(0)
    s_mov_b64 exec, s[80:81]
    v_cmpx_gt_u32 vcc, s4, v66
    ds_write2_b32 v66, v60, v122 offset1:1
    s_mov_b64 exec, s[82:83]
    v_cmpx_gt_u32 vcc, s4, v67
    ds_write2_b32 v67, v61, v123 offset1:1
    s_mov_b64 exec, s[84:85]
    v_cmpx_gt_u32 vcc, s4, v68
    ds_write2_b32 v68, v62, v124 offset1:1
    s_mov_b64 exec, s[86:87]
    v_cmpx_gt_u32 vcc, s4, v69
    ds_write2_b32 v69, v64, v125 offset1:1
    s_nop 2
    s_setpc_b64 s[88:89]
Lc_slow:
    s_lshl_b32 s4, s6, 5
    v_and_or_b32 v54, v1, 31, s4
    v_lshrrev_b32 v55, 1, v54
    v_lshlrev_b32 v55, 13, v55
    v_lshlrev_b32 v56, 4, v54
    v_and_or_b32 v55, v56, 16, v55
    v_lshrrev_b32 v56, 2, v1
    v_and_or_b32 v55, v56, 8, v55
    s_lshl_b32 s4, s3, 3
    buffer_load_dwordx2 v[52:53], v55, s[20:23], s4 offen
    v_mul_u32_u24 v50, 117760, v54
    v_mov_b32 v96, 0
    v_mov_b32 v97, 0
    v_mov_b32 v98, 0
    v_mov_b32 v99, 0
    v_lshlrev_b32 v122, 4, v0
    v_add_u32 v122, 54528, v122
    ds_write_b128 v122, v[96:99] offset:0
    ds_write_b128 v122, v[96:99] offset:16384
    ds_write_b128 v122, v[96:99] offset:32768
    v_mul_u32_u24 v58, 20, v1
    s_waitcnt vmcnt(0)
    v_and_b32 v56, 0xffff, v52
    v_lshrrev_b32 v54, 16, v52
    v_mov_b32 v52, v54
    v_and_b32 v57, 0xffff, v53
    v_lshrrev_b32 v55, 16, v53
    v_mov_b32 v53, v55
    v_add_u32_dpp v52, v52, v52 row_shr:1 row_mask:0xf bank_mask:0xf bound_ctrl:0
    s_nop 0
    v_add_u32_dpp v53, v53, v53 row_shr:1 row_mask:0xf bank_mask:0xf bound_ctrl:0
    v_add_u32_dpp v52, v52, v52 row_shr:2 row_mask:0xf bank_mask:0xf bound_ctrl:0
    s_nop 0
    v_add_u32_dpp v53, v53, v53 row_shr:2 row_mask:0xf bank_mask:0xf bound_ctrl:0
    v_add_u32_dpp v52, v52, v52 row_shr:4 row_mask:0xf bank_mask:0xf bound_ctrl:0
    s_nop 0
    v_add_u32_dpp v53, v53, v53 row_shr:4 row_mask:0xf bank_mask:0xf bound_ctrl:0
    v_add_u32_dpp v52, v52, v52 row_shr:8 row_mask:0xf bank_mask:0xf bound_ctrl:0
    s_nop 0
    v_add_u32_dpp v53, v53, v53 row_shr:8 row_mask:0xf bank_mask:0xf bound_ctrl:0
    v_add_u32_dpp v52, v52, v52 row_bcast:15 row_mask:0xa bank_mask:0xf
    s_nop 0
    v_add_u32_dpp v53, v53, v53 row_bcast:15 row_mask:0xa bank_mask:0xf
    v_add_u32_dpp v52, v52, v52 row_bcast:31 row_mask:0xc bank_mask:0xf
    s_nop 0
    v_add_u32_dpp v53, v53, v53 row_bcast:31 row_mask:0xc bank_mask:0xf
    v_readlane_b32 s8, v52, 63
    v_add_u32 v50, 12582912, v50
    v_add_u32 v56, v56, v54
    v_add_u32 v57, v57, v55
    v_add_u32 v53, s8, v53
    v_sub_u32 v56, v56, v52
    v_sub_u32 v57, v57, v53
    v_readlane_b32 s8, v53, 63
    v_mad_i32_i24 v51, v57, 20, v50
    v_mad_i32_i24 v50, v56, 20, v50
    s_mov_b32 s36, 0
    s_mov_b32 s37, 0
    s_mov_b32 s42, 0
    s_mov_b32 s90, 0
    s_mov_b32 s39, 0x40000000
    s_mov_b32 s38, -64
    s_add_u32 s41, s8, 63
    s_lshr_b32 s41, s41, 6
    s_waitcnt lgkmcnt(0)
    s_barrier
Lc_slow_loop:
    s_cmp_le_i32 s41, 0
    s_cbranch_scc1 Lc_slow_done
    s_sub_u32 s41, s41, 1
    s_add_u32 s38, s38, 64
    s_mul_i32 s40, s38, 20
    v_add_u32 v59, s39, v58
    v_mov_b32 v39, s90
Lc_run:
    s_sub_u32 s4, s37, s38
    s_cmp_ge_i32 s4, 64
    s_cbranch_scc1 Lc_built
    s_cmp_lg_u32 s36, 64
    s_cbranch_scc1 Lc_cont
    s_mov_b64 exec, -1
    v_mov_b32 v50, v51
    v_mov_b32 v52, v53
    v_mov_b32 v51, 0x40000000
    v_mov_b32 v53, 0x7fffffff
    s_mov_b32 s36, 0
Lc_cont:
    v_readlane_b32 s39, v50, s36
    v_readlane_b32 s37, v52, s36
    s_lshl_b64 exec, -1, s4
    s_add_u32 s36, s36, 1
    s_lshr_b32 s90, s42, 5
    s_mul_i32 s90, s90, 191
    s_add_u32 s42, s42, 1
    v_add_u32 v59, s39, v58
    v_mov_b32 v39, s90
    s_branch Lc_run
Lc_built:
    s_mov_b64 exec, -1
    buffer_load_dwordx4 v[40:43], v59, s[20:23], s40 offen
    buffer_load_dword v44, v59, s[20:23], s40 offen offset:16
    s_waitcnt vmcnt(0)
    v_add_u32_sdwa v46, v39, v44 dst_sel:DWORD dst_unused:UNUSED_PAD src0_sel:DWORD src1_sel:BYTE_0
    v_mul_u32_u24 v79, 448, v46
    v_and_b32 v78, 0x1ff, v40
    v_add_u32 v78, v78, v79
    buffer_load_dwordx2 v[78:79], v78, s[12:15], 0 idxen
    v_add_u32_sdwa v47, v39, v44 dst_sel:DWORD dst_unused:UNUSED_PAD src0_sel:DWORD src1_sel:BYTE_1
    v_mul_u32_u24 v81, 448, v47
    v_and_b32 v80, 0x1ff, v41
    v_add_u32 v80, v80, v81
    buffer_load_dwordx2 v[80:81], v80, s[12:15], 0 idxen
    v_add_u32_sdwa v48, v39, v44 dst_sel:DWORD dst_unused:UNUSED_PAD src0_sel:DWORD src1_sel:BYTE_2
    v_mul_u32_u24 v83, 448, v48
    v_and_b32 v82, 0x1ff, v42
    v_add_u32 v82, v82, v83
    buffer_load_dwordx2 v[82:83], v82, s[12:15], 0 idxen
    v_add_u32_sdwa v49, v39, v44 dst_sel:DWORD dst_unused:UNUSED_PAD src0_sel:DWORD src1_sel:BYTE_3
    v_mul_u32_u24 v85, 448, v49
    v_and_b32 v84, 0x1ff, v43
    v_add_u32 v84, v84, v85
    buffer_load_dwordx2 v[84:85], v84, s[12:15], 0 idxen
    v_lshrrev_b32 v102, 6, v40
    v_cvt_f32_i32 v103, v40
    v_and_b32 v102, 0x3ff8, v102
    v_add_u32 v105, v102, v102
    ds_read_b64 v[100:101], v102 offset:23808
    ds_read_b128 v[96:99], v105 offset:3328
    v_fmaak_f32 v105, v103, v103, 0xddffc004
    v_fmaak_f32 v104, v105, v7, 0xb0001002
    v_mul_f32 v104, v104, v103
    v_cvt_pk_bf16_f32 v103, v103, v105
    s_waitcnt vmcnt(0) lgkmcnt(0)
    v_cmpx_ne_u32 vcc, v39, v46
    v_pk_mul_f32 v[116:117], v[100:101], v[104:105] op_sel_hi:[1,0]
    v_fma_mix_f32 v118, v100, v104, 0 op_sel_hi:[1,0,0]
    v_fma_mix_f32 v119, v101, v104, 0 op_sel_hi:[1,0,0]
    v_dot2c_f32_bf16 v116, v97, v103
    v_dot2c_f32_bf16 v117, v99, v103
    v_dot2c_f32_bf16 v118, v96, v103
    v_dot2c_f32_bf16 v119, v98, v103
    v_lshlrev_b32 v120, 16, v78
    v_lshlrev_b32 v121, 16, v79
    v_add_u32 v102, 54528, v102
    v_mul_f32 v118, v120, v118
    v_mul_f32 v116, v78, v116
    v_mul_f32 v119, v121, v119
    v_mul_f32 v117, v79, v117
    v_cvt_f64_f32 v[88:89], v116
    v_cvt_f64_f32 v[90:91], v117
    v_cvt_f64_f32 v[92:93], v118
    v_cvt_f64_f32 v[94:95], v119
    ds_add_f64 v102, v[88:89] offset:0
    ds_add_f64 v102, v[90:91] offset:10240
    ds_add_f64 v102, v[92:93] offset:20480
    ds_add_f64 v102, v[94:95] offset:30720
    s_mov_b64 exec, -1
    v_lshrrev_b32 v102, 6, v41
    v_cvt_f32_i32 v103, v41
    v_and_b32 v102, 0x3ff8, v102
    v_add_u32 v105, v102, v102
    ds_read_b64 v[100:101], v102 offset:23808
    ds_read_b128 v[96:99], v105 offset:3328
    v_fmaak_f32 v105, v103, v103, 0xddffc004
    v_fmaak_f32 v104, v105, v7, 0xb0001002
    v_mul_f32 v104, v104, v103
    v_cvt_pk_bf16_f32 v103, v103, v105
    s_waitcnt vmcnt(0) lgkmcnt(0)
    v_cmpx_ne_u32 vcc, v39, v47
    v_pk_mul_f32 v[116:117], v[100:101], v[104:105] op_sel_hi:[1,0]
    v_fma_mix_f32 v118, v100, v104, 0 op_sel_hi:[1,0,0]
    v_fma_mix_f32 v119, v101, v104, 0 op_sel_hi:[1,0,0]
    v_dot2c_f32_bf16 v116, v97, v103
    v_dot2c_f32_bf16 v117, v99, v103
    v_dot2c_f32_bf16 v118, v96, v103
    v_dot2c_f32_bf16 v119, v98, v103
    v_lshlrev_b32 v120, 16, v80
    v_lshlrev_b32 v121, 16, v81
    v_add_u32 v102, 54528, v102
    v_mul_f32 v118, v120, v118
    v_mul_f32 v116, v80, v116
    v_mul_f32 v119, v121, v119
    v_mul_f32 v117, v81, v117
    v_cvt_f64_f32 v[88:89], v116
    v_cvt_f64_f32 v[90:91], v117
    v_cvt_f64_f32 v[92:93], v118
    v_cvt_f64_f32 v[94:95], v119
    ds_add_f64 v102, v[88:89] offset:0
    ds_add_f64 v102, v[90:91] offset:10240
    ds_add_f64 v102, v[92:93] offset:20480
    ds_add_f64 v102, v[94:95] offset:30720
    s_mov_b64 exec, -1
    v_lshrrev_b32 v102, 6, v42
    v_cvt_f32_i32 v103, v42
    v_and_b32 v102, 0x3ff8, v102
    v_add_u32 v105, v102, v102
    ds_read_b64 v[100:101], v102 offset:23808
    ds_read_b128 v[96:99], v105 offset:3328
    v_fmaak_f32 v105, v103, v103, 0xddffc004
    v_fmaak_f32 v104, v105, v7, 0xb0001002
    v_mul_f32 v104, v104, v103
    v_cvt_pk_bf16_f32 v103, v103, v105
    s_waitcnt vmcnt(0) lgkmcnt(0)
    v_cmpx_ne_u32 vcc, v39, v48
    v_pk_mul_f32 v[116:117], v[100:101], v[104:105] op_sel_hi:[1,0]
    v_fma_mix_f32 v118, v100, v104, 0 op_sel_hi:[1,0,0]
    v_fma_mix_f32 v119, v101, v104, 0 op_sel_hi:[1,0,0]
    v_dot2c_f32_bf16 v116, v97, v103
    v_dot2c_f32_bf16 v117, v99, v103
    v_dot2c_f32_bf16 v118, v96, v103
    v_dot2c_f32_bf16 v119, v98, v103
    v_lshlrev_b32 v120, 16, v82
    v_lshlrev_b32 v121, 16, v83
    v_add_u32 v102, 54528, v102
    v_mul_f32 v118, v120, v118
    v_mul_f32 v116, v82, v116
    v_mul_f32 v119, v121, v119
    v_mul_f32 v117, v83, v117
    v_cvt_f64_f32 v[88:89], v116
    v_cvt_f64_f32 v[90:91], v117
    v_cvt_f64_f32 v[92:93], v118
    v_cvt_f64_f32 v[94:95], v119
    ds_add_f64 v102, v[88:89] offset:0
    ds_add_f64 v102, v[90:91] offset:10240
    ds_add_f64 v102, v[92:93] offset:20480
    ds_add_f64 v102, v[94:95] offset:30720
    s_mov_b64 exec, -1
    v_lshrrev_b32 v102, 6, v43
    v_cvt_f32_i32 v103, v43
    v_and_b32 v102, 0x3ff8, v102
    v_add_u32 v105, v102, v102
    ds_read_b64 v[100:101], v102 offset:23808
    ds_read_b128 v[96:99], v105 offset:3328
    v_fmaak_f32 v105, v103, v103, 0xddffc004
    v_fmaak_f32 v104, v105, v7, 0xb0001002
    v_mul_f32 v104, v104, v103
    v_cvt_pk_bf16_f32 v103, v103, v105
    s_waitcnt vmcnt(0) lgkmcnt(0)
    v_cmpx_ne_u32 vcc, v39, v49
    v_pk_mul_f32 v[116:117], v[100:101], v[104:105] op_sel_hi:[1,0]
    v_fma_mix_f32 v118, v100, v104, 0 op_sel_hi:[1,0,0]
    v_fma_mix_f32 v119, v101, v104, 0 op_sel_hi:[1,0,0]
    v_dot2c_f32_bf16 v116, v97, v103
    v_dot2c_f32_bf16 v117, v99, v103
    v_dot2c_f32_bf16 v118, v96, v103
    v_dot2c_f32_bf16 v119, v98, v103
    v_lshlrev_b32 v120, 16, v84
    v_lshlrev_b32 v121, 16, v85
    v_add_u32 v102, 54528, v102
    v_mul_f32 v118, v120, v118
    v_mul_f32 v116, v84, v116
    v_mul_f32 v119, v121, v119
    v_mul_f32 v117, v85, v117
    v_cvt_f64_f32 v[88:89], v116
    v_cvt_f64_f32 v[90:91], v117
    v_cvt_f64_f32 v[92:93], v118
    v_cvt_f64_f32 v[94:95], v119
    ds_add_f64 v102, v[88:89] offset:0
    ds_add_f64 v102, v[90:91] offset:10240
    ds_add_f64 v102, v[92:93] offset:20480
    ds_add_f64 v102, v[94:95] offset:30720
    s_mov_b64 exec, -1
    s_branch Lc_slow_loop
Lc_slow_done:
    s_waitcnt lgkmcnt(0)
    s_barrier
    v_lshlrev_b32 v122, 3, v0
    v_add_u32 v122, 54528, v122
    ds_read_b64 v[96:97], v122 offset:0
    ds_read_b64 v[98:99], v122 offset:10240
    ds_read_b64 v[100:101], v122 offset:20480
    ds_read_b64 v[102:103], v122 offset:30720
    ds_read_b64 v[104:105], v122 offset:8192
    ds_read_b64 v[106:107], v122 offset:18432
    ds_read_b64 v[108:109], v122 offset:28672
    ds_read_b64 v[110:111], v122 offset:38912
    s_waitcnt lgkmcnt(0)
    v_cvt_f32_f64 v18, v[96:97]
    v_cvt_f32_f64 v19, v[98:99]
    v_cvt_f32_f64 v20, v[100:101]
    v_cvt_f32_f64 v21, v[102:103]
    v_cvt_f32_f64 v22, v[104:105]
    v_cvt_f32_f64 v23, v[106:107]
    v_cvt_f32_f64 v24, v[108:109]
    v_cvt_f32_f64 v25, v[110:111]
    v_cvt_pk_bf16_f32 v18, v20, v18
    v_cvt_pk_bf16_f32 v19, v21, v19
    v_dot2_f32_bf16 v96, v18, s92, 0
    v_dot2_f32_bf16 v97, v18, s93, 0
    v_dot2_f32_bf16 v98, v18, s94, 0
    v_dot2_f32_bf16 v99, v18, s95, 0
    v_dot2_f32_bf16 v96, v19, s96, v96
    v_dot2_f32_bf16 v97, v19, s97, v97
    v_dot2_f32_bf16 v98, v19, s98, v98
    v_dot2_f32_bf16 v99, v19, s99, v99
    v_cvt_pk_bf16_f32 v96, 0, v96
    v_cvt_pk_bf16_f32 v97, 0, v97
    v_cvt_pk_bf16_f32 v98, 0, v98
    v_cvt_pk_bf16_f32 v99, 0, v99
    v_mul_f32 v96, v96, v64
    v_mul_f32 v97, v97, v65
    v_mul_f32 v98, v98, v66
    v_mul_f32 v99, v99, v67
    v_cvt_pk_bf16_f32 v96, 0, v96
    v_cvt_pk_bf16_f32 v97, 0, v97
    v_cvt_pk_bf16_f32 v98, 0, v98
    v_cvt_pk_bf16_f32 v99, 0, v99
    v_add_f32 v96, v96, v60
    v_add_f32 v97, v97, v61
    v_add_f32 v98, v98, v62
    v_add_f32 v99, v99, v63
    v_cvt_pk_bf16_f32 v30, v96, v97
    v_cvt_pk_bf16_f32 v31, v98, v99
    buffer_store_dwordx2 v[30:31], v32, s[28:31], 0 offen sc1
    s_cmp_ge_u32 s6, 4
    s_cbranch_scc1 Lc_done
    v_cvt_pk_bf16_f32 v22, v24, v22
    v_cvt_pk_bf16_f32 v23, v25, v23
    v_dot2_f32_bf16 v96, v22, s92, 0
    v_dot2_f32_bf16 v97, v22, s93, 0
    v_dot2_f32_bf16 v98, v22, s94, 0
    v_dot2_f32_bf16 v99, v22, s95, 0
    v_dot2_f32_bf16 v96, v23, s96, v96
    v_dot2_f32_bf16 v97, v23, s97, v97
    v_dot2_f32_bf16 v98, v23, s98, v98
    v_dot2_f32_bf16 v99, v23, s99, v99
    v_cvt_pk_bf16_f32 v96, 0, v96
    v_cvt_pk_bf16_f32 v97, 0, v97
    v_cvt_pk_bf16_f32 v98, 0, v98
    v_cvt_pk_bf16_f32 v99, 0, v99
    v_mul_f32 v96, v96, v72
    v_mul_f32 v97, v97, v73
    v_mul_f32 v98, v98, v74
    v_mul_f32 v99, v99, v75
    v_cvt_pk_bf16_f32 v96, 0, v96
    v_cvt_pk_bf16_f32 v97, 0, v97
    v_cvt_pk_bf16_f32 v98, 0, v98
    v_cvt_pk_bf16_f32 v99, 0, v99
    v_add_f32 v96, v96, v68
    v_add_f32 v97, v97, v69
    v_add_f32 v98, v98, v70
    v_add_f32 v99, v99, v71
    v_cvt_pk_bf16_f32 v34, v96, v97
    v_cvt_pk_bf16_f32 v35, v98, v99
    buffer_store_dwordx2 v[34:35], v36, s[28:31], 0 offen sc1
    s_branch Lc_done
.section .rodata,"a"
.p2align 6
.amdhsa_kernel p_kernel
  .amdhsa_next_free_vgpr 128
  .amdhsa_next_free_sgpr 102
  .amdhsa_accum_offset 128
  .amdhsa_group_segment_fixed_size 0
  .amdhsa_kernarg_size 112
  .amdhsa_user_sgpr_count 2
  .amdhsa_user_sgpr_kernarg_segment_ptr 1
  .amdhsa_system_sgpr_workgroup_id_x 1
  .amdhsa_float_denorm_mode_32 3
.end_amdhsa_kernel
.p2align 6
.amdhsa_kernel c_kernel
  .amdhsa_next_free_vgpr 128
  .amdhsa_next_free_sgpr 102
  .amdhsa_accum_offset 128
  .amdhsa_group_segment_fixed_size 0
  .amdhsa_kernarg_size 112
  .amdhsa_user_sgpr_count 2
  .amdhsa_user_sgpr_kernarg_segment_ptr 1
  .amdhsa_system_sgpr_workgroup_id_x 1
  .amdhsa_float_denorm_mode_32 3
.end_amdhsa_kernel
```
